```python
import torch

def _softmax(x, axis=-1):
    return torch.softmax(x, dim=axis)
def _gelu(x):
    return torch.nn.functional.gelu(x, approximate="tanh")
def _silu(x):
    return torch.nn.functional.silu(x)
def _sigmoid(x):
    return torch.sigmoid(x)
def _layernorm(x, axis=-1, eps=1e-5):
    m = x.mean(dim=axis, keepdim=True)
    v = x.var(dim=axis, keepdim=True, unbiased=False)
    return (x - m) / torch.sqrt(v + eps)
def _scatter_add(tgt, idx, src, axis=0):
    return tgt.clone().index_add_(axis, idx, src)
def _segment_sum(src, seg, n):
    out = torch.zeros((n,) + src.shape[1:], dtype=src.dtype)
    return out.index_add_(0, seg, src)
def _pad(x, pw):
    flat = tuple(v for pair in reversed(pw) for v in pair)
    return torch.nn.functional.pad(x, flat)

kernel_name = 'standalone__mha_block_cached__near_ridge'

def setup_inputs():

    _w = (lambda a: (lambda t: t.to(torch.bfloat16) if t.is_floating_point() else t)(torch.as_tensor(a)))
    B, Sq, D = 8, 192, 576
    H, Sk, Dh = 32, 2048, 128
    return {
        "x": _w((lambda *s: torch.randn(*s, dtype=torch.bfloat16) * 0.8)(B, Sq, D)),
        "k_cache": _w((lambda *s: torch.randn(*s, dtype=torch.bfloat16) * 0.8)(B, H, Sk, Dh)),
        "v_cache": _w((lambda *s: torch.randn(*s, dtype=torch.bfloat16) * 0.05)(B, H, Sk, Dh)),
        "wq": _w((lambda *s: torch.randn(*s, dtype=torch.bfloat16) * 0.8)(D, H * Dh) * (D ** -0.5)),
        "wo": _w((lambda *s: torch.randn(*s, dtype=torch.bfloat16) * 0.05)(H * Dh, D) * ((H * Dh) ** -0.5)),
    }

def reference(x, k_cache, v_cache, wq, wo):
    B, Sq, D = x.shape
    H, Dh = 32, 128
    q = (lambda x, *d: x.permute(*d))((x @ wq).reshape(B, Sq, H, Dh), 0, 2, 1, 3)
    scores = torch.einsum("bhqd,bhkd->bhqk", q, k_cache) * (Dh ** -0.5)
    p = _softmax(scores, axis=-1)
    o = torch.einsum("bhqk,bhkd->bhqd", p, v_cache)
    return (lambda x, *d: x.permute(*d))(o, 0, 2, 1, 3).reshape(B, Sq, H * Dh) @ wo
```

```asm
; @launch grid=(256,1,1) block=(256,1,1) lds=163840
.amdgcn_target "amdgcn-amd-amdhsa--gfx950"
.text
.globl standalone__mha_block_cached__near_ridge_kernel
.p2align 8
.type standalone__mha_block_cached__near_ridge_kernel,@function
standalone__mha_block_cached__near_ridge_kernel:
  s_cmp_ge_u32 s2, 256
  s_cbranch_scc1 L_k1_end
  s_load_dwordx4 s[4:7], s[0:1], 0
  s_load_dwordx4 s[28:31], s[0:1], 16
  s_load_dwordx2 s[32:33], s[0:1], 56
  s_load_dwordx2 s[58:59], s[0:1], 32
  s_load_dwordx4 s[88:91], s[0:1], 40
  v_lshrrev_b32 v1, 6, v0
  s_mov_b32 s41, 0
  v_readfirstlane_b32 s3, v1
  s_and_b32 s44, s2, 7
  s_lshr_b32 s45, s2, 3
  s_and_b32 s46, s44, 1

  s_lshl_b32 s46, s46, 2
  s_and_b32 s47, s45, 3
  s_add_u32 s34, s46, s47
  s_lshr_b32 s46, s44, 1
  s_lshl_b32 s46, s46, 3
  s_lshr_b32 s47, s45, 2
  s_add_u32 s35, s46, s47
  s_and_b32 s36, s3, 1
  s_lshr_b32 s37, s3, 1
L_restart:
  v_mbcnt_lo_u32_b32 v2, -1, 0
  v_mbcnt_hi_u32_b32 v2, -1, v2
  v_lshrrev_b32 v3, 4, v2
  v_and_b32 v4, 15, v2
  v_lshrrev_b32 v5, 3, v2
  v_mul_u32_u24 v5, 1152, v5
  v_and_b32 v6, 7, v2
  v_xor_b32 v6, v6, v3
  v_lshl_add_u32 v236, v6, 4, v5
  v_xor_b32 v6, 4, v6
  v_lshl_add_u32 v7, v6, 4, v5
  v_add_u32 v237, 8192, v7
  v_add_u32 v238, 16384, v236
  v_add_u32 v239, 24576, v7
  v_add_u32 v240, 36864, v236
  v_add_u32 v241, 45056, v7
  v_lshlrev_b32 v5, 2, v3
  v_xor_b32 v5, v5, v4
  v_lshlrev_b32 v5, 4, v5
  v_lshl_add_u32 v242, v3, 13, v5
  v_add_u32 v243, 31744, v242
  v_add_u32 v244, 63488, v242
  v_add_u32 v245, 95232, v242
  s_mul_i32 s51, s3, 6144
  s_mul_i32 s54, s3, 55296
  s_lshl_b32 s50, s3, 12
  s_add_u32 s50, s50, 24576
  s_lshl_b32 s55, s3, 17
  s_lshl_b32 s43, s3, 12
  s_and_b32 s44, s34, 3
  s_mul_i32 s44, s44, 2
  s_and_b32 s45, s35, 7
  s_mul_i32 s45, s45, 1
  s_add_u32 s44, s44, s45
  s_sub_u32 s45, s44, 9
  s_cmp_ge_u32 s44, 9
  s_cselect_b32 s56, s45, s44
  s_mul_i32 s45, s34, 221184
  s_lshl_b32 s46, s35, 8
  s_waitcnt lgkmcnt(0)
  s_add_u32 s20, s30, s46
  s_addc_u32 s21, s31, 0
  s_and_b32 s21, s21, 0xffff
  s_sub_u32 s22, 4718592, s46
  s_mov_b32 s23, 0x20000
  s_add_u32 s16, s4, s45
  s_addc_u32 s17, s5, 0
  s_and_b32 s17, s17, 0xffff
  s_mov_b32 s18, 221184
  s_mov_b32 s19, 0x20000
  s_lshl_b32 s45, s56, 19
  s_add_u32 m0, s50, 0
  s_add_u32 s45, s45, s55
  buffer_load_dwordx4 v242, s[20:23], s45 offen offset:0 lds
  buffer_load_dwordx4 v243, s[20:23], s45 offen offset:1024 lds
  buffer_load_dwordx4 v244, s[20:23], s45 offen offset:2048 lds
  buffer_load_dwordx4 v245, s[20:23], s45 offen offset:3072 lds
  s_lshl_b32 s44, s56, 7
  s_add_u32 m0, s51, 0
  s_add_u32 s44, s44, s54
  buffer_load_dwordx4 v236, s[16:19], s44 offen offset:0 lds
  buffer_load_dwordx4 v237, s[16:19], s44 offen offset:1024 lds
  buffer_load_dwordx4 v238, s[16:19], s44 offen offset:2048 lds
  buffer_load_dwordx4 v239, s[16:19], s44 offen offset:3072 lds
  s_add_u32 m0, s51, 4096
  s_nop 0
  buffer_load_dwordx4 v240, s[16:19], s44 offen offset:0 lds
  buffer_load_dwordx4 v241, s[16:19], s44 offen offset:1024 lds
  s_add_u32 s56, s56, 1
  s_cmp_eq_u32 s56, 9
  s_cselect_b32 s56, 0, s56
  s_lshl_b32 s45, s56, 19
  s_add_u32 m0, s50, 40960
  s_add_u32 s45, s45, s55
  buffer_load_dwordx4 v242, s[20:23], s45 offen offset:0 lds
  buffer_load_dwordx4 v243, s[20:23], s45 offen offset:1024 lds
  buffer_load_dwordx4 v244, s[20:23], s45 offen offset:2048 lds
  buffer_load_dwordx4 v245, s[20:23], s45 offen offset:3072 lds
  s_lshl_b32 s44, s56, 7
  s_add_u32 m0, s51, 40960
  s_add_u32 s44, s44, s54
  buffer_load_dwordx4 v236, s[16:19], s44 offen offset:0 lds
  buffer_load_dwordx4 v237, s[16:19], s44 offen offset:1024 lds
  buffer_load_dwordx4 v238, s[16:19], s44 offen offset:2048 lds
  buffer_load_dwordx4 v239, s[16:19], s44 offen offset:3072 lds
  s_add_u32 m0, s51, 45056
  s_nop 0
  buffer_load_dwordx4 v240, s[16:19], s44 offen offset:0 lds
  buffer_load_dwordx4 v241, s[16:19], s44 offen offset:1024 lds
  s_lshl_b32 s44, s34, 5
  s_add_u32 s44, s44, s35
  s_lshl_b32 s44, s44, 19
  s_add_u32 s8, s6, s44
  s_addc_u32 s9, s7, 0
  s_and_b32 s9, s9, 0xffff
  s_mov_b32 s10, 0x80000
  s_mov_b32 s11, 0x20000
  s_add_u32 s12, s28, s44
  s_addc_u32 s13, s29, 0
  s_and_b32 s13, s13, 0xffff
  s_mov_b32 s14, 0x80000
  s_mov_b32 s15, 0x20000
  s_or_b32 s44, s3, s41
  s_cmp_eq_u32 s44, 0
  s_cselect_b32 s92, 7, 99
  s_add_u32 s94, s32, 0x1000000
  s_addc_u32 s95, s33, 0
  s_or_b32 s44, s44, s35
  s_cmp_eq_u32 s44, 0
  s_cbranch_scc0 L_nozero
  v_lshlrev_b32 v13, 8, v2
  s_lshl_b32 s44, s34, 13
  v_add_u32 v13, s44, v13
  v_mov_b32 v14, 0
  s_mov_b32 exec_hi, 0
  global_store_dword v13, v14, s[94:95] sc1
  s_mov_b64 exec, -1
L_nozero:
  v_add_u32 v7, 0, v3
  v_xor_b32 v7, v7, v4
  v_lshlrev_b32 v7, 4, v7
  v_lshl_add_u32 v220, v3, 8, v7
  v_add_u32 v7, 4, v3
  v_xor_b32 v7, v7, v4
  v_lshlrev_b32 v7, 4, v7
  v_lshl_add_u32 v221, v3, 8, v7
  v_add_u32 v7, 8, v3
  v_xor_b32 v7, v7, v4
  v_lshlrev_b32 v7, 4, v7
  v_lshl_add_u32 v222, v3, 8, v7
  v_add_u32 v7, 12, v3
  v_xor_b32 v7, v7, v4
  v_lshlrev_b32 v7, 4, v7
  v_lshl_add_u32 v223, v3, 8, v7
  v_add_u32 v7, 0, v3
  v_lshlrev_b32 v7, 1, v7
  v_xor_b32 v7, v7, v4
  v_lshlrev_b32 v7, 4, v7
  v_lshl_add_u32 v224, v3, 8, v7
  v_add_u32 v7, 4, v3
  v_lshlrev_b32 v7, 1, v7
  v_xor_b32 v7, v7, v4
  v_lshlrev_b32 v7, 4, v7
  v_lshl_add_u32 v225, v3, 8, v7
  v_lshrrev_b32 v9, 2, v4
  v_and_b32 v10, 3, v4
  v_lshlrev_b32 v11, 2, v9
  v_xor_b32 v11, v11, v10
  v_lshlrev_b32 v11, 4, v11
  v_lshl_add_u32 v12, v3, 3, v9
  v_lshl_add_u32 v11, v12, 8, v11
  s_lshl_b32 s45, s37, 7
  v_xor_b32 v11, s45, v11
  v_xor_b32 v12, 0, v11
  v_add_u32 v232, 24576, v12
  v_add_u32 v234, 139264, v12
  v_xor_b32 v12, 64, v11
  v_add_u32 v233, 24576, v12
  v_add_u32 v235, 139264, v12
  v_lshrrev_b32 v11, 1, v4
  v_xor_b32 v11, v11, v3
  v_lshlrev_b32 v11, 4, v11
  v_lshl_add_u32 v11, v4, 7, v11
  s_mul_i32 s44, s36, 12288
  v_add_u32 v11, s44, v11
  v_mov_b32 v228, v11
  v_xor_b32 v229, 64, v11
  v_add_u32 v230, 114688, v228
  v_add_u32 v231, 114688, v229
  s_lshl_b32 s44, s37, 13
  v_xor_b32 v8, v3, v4
  v_lshlrev_b32 v8, 4, v8
  v_lshl_add_u32 v8, v4, 8, v8
  v_xor_b32 v8, s45, v8
  v_add_u32 v8, s44, v8
  v_lshlrev_b32 v13, 4, v3
  v_add_u32 v13, s44, v13
  v_add_u32 v13, 0x10000, v13
  v_add_u32 v254, s45, v13
  s_xor_b32 s46, s45, 128
  v_add_u32 v255, s46, v13
  s_mov_b32 s98, 0xbf800000
  s_mov_b32 s99, 0xbf800000
  v_xor_b32 v196, 0, v8
  v_add_u32 v200, 0x10000, v196
  v_xor_b32 v197, 64, v8
  v_add_u32 v201, 0x10000, v197
  v_xor_b32 v198, 128, v8
  v_add_u32 v202, 0x10000, v198
  v_xor_b32 v199, 192, v8
  v_add_u32 v203, 0x10000, v199
  v_and_b32 v11, 1, v3
  v_lshl_add_u32 v11, v11, 2, v9
  v_lshlrev_b32 v11, 1, v11
  v_lshrrev_b32 v12, 1, v10
  v_xor_b32 v11, v11, v12
  v_lshlrev_b32 v11, 4, v11
  v_and_b32 v12, 1, v10
  v_lshl_add_u32 v11, v12, 3, v11
  v_lshl_add_u32 v12, v3, 2, v9
  v_lshl_add_u32 v11, v12, 8, v11
  v_add_u32 v11, s44, v11
  v_add_u32 v11, 16384, v11
  v_xor_b32 v204, 0, v11
  v_add_u32 v212, 0x10000, v204
  v_xor_b32 v205, 32, v11
  v_add_u32 v213, 0x10000, v205
  v_xor_b32 v206, 64, v11
  v_add_u32 v214, 0x10000, v206
  v_xor_b32 v207, 96, v11
  v_add_u32 v215, 0x10000, v207
  v_xor_b32 v208, 128, v11
  v_add_u32 v216, 0x10000, v208
  v_xor_b32 v209, 160, v11
  v_add_u32 v217, 0x10000, v209
  v_xor_b32 v210, 192, v11
  v_add_u32 v218, 0x10000, v210
  v_xor_b32 v211, 224, v11
  v_add_u32 v219, 0x10000, v211
  v_cmp_eq_u32 vcc, 0, v10
  v_mov_b32 v12, 0x3f803f80
  v_cndmask_b32 v192, 0, v12, vcc
  v_mov_b32 v193, v192
  v_mov_b32 v194, v192
  v_mov_b32 v195, v192
  v_lshlrev_b32 v226, 4, v2
  s_mul_i32 s44, s3, 12288
  s_add_u32 s44, s44, 114688
  v_add_u32 v252, s44, v226
  s_xor_b32 s45, s3, 2
  s_mul_i32 s44, s45, 12288
  s_add_u32 s44, s44, 114688
  v_add_u32 v253, s44, v226
  s_mov_b32 s48, 0x3e0293ee
  s_mov_b32 s49, 0x3e0293ee
  s_add_u32 s38, s43, 65536
  s_add_u32 s39, s43, 49152
  s_waitcnt vmcnt(10)
  s_barrier
  ds_read_b64_tr_b16 v[0:1], v232 offset:0
  ds_read_b64_tr_b16 v[2:3], v232 offset:1024
  ds_read_b128 v[32:35], v228 offset:0
  ds_read_b128 v[36:39], v228 offset:2048
  ds_read_b128 v[40:43], v228 offset:4096
  ds_read_b128 v[44:47], v228 offset:6144
  ds_read_b128 v[48:51], v228 offset:8192
  ds_read_b128 v[52:55], v228 offset:10240
  ds_read_b64_tr_b16 v[4:5], v232 offset:8
  ds_read_b64_tr_b16 v[6:7], v232 offset:1032
  ds_read_b64_tr_b16 v[8:9], v233 offset:0
  ds_read_b64_tr_b16 v[10:11], v233 offset:1024
  ds_read_b64_tr_b16 v[12:13], v233 offset:8
  ds_read_b64_tr_b16 v[14:15], v233 offset:1032
  s_waitcnt lgkmcnt(0)
  v_mfma_f32_16x16x32_bf16 v[96:99], v[0:3], v[32:35], 0
  ds_read_b64_tr_b16 v[16:17], v232 offset:8192
  s_add_u32 s56, s56, 1
  s_cmp_eq_u32 s56, 9
  s_cselect_b32 s56, 0, s56
  s_lshl_b32 s45, s56, 19
  s_add_u32 m0, s50, 114688
  s_add_u32 s45, s45, s55
  buffer_load_dwordx4 v242, s[20:23], s45 offen offset:0 lds
  v_mfma_f32_16x16x32_bf16 v[100:103], v[0:3], v[36:39], 0
  ds_read_b64_tr_b16 v[18:19], v232 offset:9216
  v_accvgpr_write_b32 a22, 0
  v_mfma_f32_16x16x32_bf16 v[104:107], v[0:3], v[40:43], 0
  ds_read_b128 v[56:59], v229 offset:0
  buffer_load_dwordx4 v243, s[20:23], s45 offen offset:1024 lds
  v_mfma_f32_16x16x32_bf16 v[108:111], v[0:3], v[44:47], 0
  ds_read_b128 v[60:63], v229 offset:2048
  v_accvgpr_write_b32 a21, 0
  v_mfma_f32_16x16x32_bf16 v[112:115], v[0:3], v[48:51], 0
  ds_read_b128 v[64:67], v229 offset:4096
  buffer_load_dwordx4 v244, s[20:23], s45 offen offset:2048 lds
  v_mfma_f32_16x16x32_bf16 v[116:119], v[0:3], v[52:55], 0
  ds_read_b128 v[68:71], v229 offset:6144
  v_accvgpr_write_b32 a20, 0
  v_mfma_f32_16x16x32_bf16 v[120:123], v[4:7], v[32:35], 0
  ds_read_b128 v[72:75], v229 offset:8192
  v_accvgpr_write_b32 a19, 0
  v_mfma_f32_16x16x32_bf16 v[124:127], v[4:7], v[36:39], 0
  ds_read_b128 v[76:79], v229 offset:10240
  buffer_load_dwordx4 v245, s[20:23], s45 offen offset:3072 lds
  v_mfma_f32_16x16x32_bf16 v[128:131], v[4:7], v[40:43], 0
  ds_read_b64_tr_b16 v[20:21], v232 offset:8200
  v_accvgpr_write_b32 a18, 0
  v_mfma_f32_16x16x32_bf16 v[132:135], v[4:7], v[44:47], 0
  ds_read_b64_tr_b16 v[22:23], v232 offset:9224
  s_lshl_b32 s44, s56, 7
  s_add_u32 m0, s51, 114688
  s_add_u32 s44, s44, s54
  buffer_load_dwordx4 v236, s[16:19], s44 offen offset:0 lds
  v_mfma_f32_16x16x32_bf16 v[136:139], v[4:7], v[48:51], 0
  ds_read_b64_tr_b16 v[24:25], v233 offset:8192
  v_accvgpr_write_b32 a17, 0
  v_mfma_f32_16x16x32_bf16 v[140:143], v[4:7], v[52:55], 0
  ds_read_b64_tr_b16 v[26:27], v233 offset:9216
  v_accvgpr_write_b32 a16, 0
  v_mfma_f32_16x16x32_bf16 v[144:147], v[8:11], v[32:35], 0
  ds_read_b64_tr_b16 v[28:29], v233 offset:8200
  buffer_load_dwordx4 v237, s[16:19], s44 offen offset:1024 lds
  v_mfma_f32_16x16x32_bf16 v[148:151], v[8:11], v[36:39], 0
  ds_read_b64_tr_b16 v[30:31], v233 offset:9224
  v_accvgpr_write_b32 a15, 0
  v_mfma_f32_16x16x32_bf16 v[152:155], v[8:11], v[40:43], 0
  buffer_load_dwordx4 v238, s[16:19], s44 offen offset:2048 lds
  v_accvgpr_write_b32 a14, 0
  v_mfma_f32_16x16x32_bf16 v[156:159], v[8:11], v[44:47], 0
  v_accvgpr_write_b32 a5, 0
  v_accvgpr_write_b32 a13, 0
  v_mfma_f32_16x16x32_bf16 v[160:163], v[8:11], v[48:51], 0
  buffer_load_dwordx4 v239, s[16:19], s44 offen offset:3072 lds
  v_accvgpr_write_b32 a12, 0
  v_mfma_f32_16x16x32_bf16 v[164:167], v[8:11], v[52:55], 0
  v_accvgpr_write_b32 a4, 0
  v_accvgpr_write_b32 a11, 0
  v_mfma_f32_16x16x32_bf16 v[168:171], v[12:15], v[32:35], 0
  v_accvgpr_write_b32 a3, 0
  v_accvgpr_write_b32 a10, 0
  v_mfma_f32_16x16x32_bf16 v[172:175], v[12:15], v[36:39], 0
  s_add_u32 m0, s51, 118784
  s_nop 0
  buffer_load_dwordx4 v240, s[16:19], s44 offen offset:0 lds
  v_mfma_f32_16x16x32_bf16 v[176:179], v[12:15], v[40:43], 0
  v_accvgpr_write_b32 a2, 0
  v_accvgpr_write_b32 a9, 0
  v_mfma_f32_16x16x32_bf16 v[180:183], v[12:15], v[44:47], 0
  buffer_load_dwordx4 v241, s[16:19], s44 offen offset:1024 lds
  v_accvgpr_write_b32 a8, 0
  v_mfma_f32_16x16x32_bf16 v[184:187], v[12:15], v[48:51], 0
  v_accvgpr_write_b32 a1, 0
  v_accvgpr_write_b32 a7, 0
  v_accvgpr_write_b32 a24, 0
  v_mfma_f32_16x16x32_bf16 v[188:191], v[12:15], v[52:55], 0
  v_accvgpr_write_b32 a0, 0
  v_accvgpr_write_b32 a6, 0
  v_accvgpr_write_b32 a23, 0
  s_waitcnt lgkmcnt(0)
  s_waitcnt vmcnt(10)
  s_barrier
  v_mfma_f32_16x16x32_bf16 v[96:99], v[16:19], v[56:59], v[96:99]
  ds_read_b64_tr_b16 v[0:1], v232 offset:40960
  s_add_u32 s56, s56, 1
  s_cmp_eq_u32 s56, 9
  s_cselect_b32 s56, 0, s56
  s_lshl_b32 s45, s56, 19
  s_add_u32 m0, s50, 0
  s_add_u32 s45, s45, s55
  buffer_load_dwordx4 v242, s[20:23], s45 offen offset:0 lds
  v_mfma_f32_16x16x32_bf16 v[100:103], v[16:19], v[60:63], v[100:103]
  ds_read_b64_tr_b16 v[2:3], v232 offset:41984
  v_mfma_f32_16x16x32_bf16 v[104:107], v[16:19], v[64:67], v[104:107]
  ds_read_b128 v[32:35], v228 offset:40960
  buffer_load_dwordx4 v243, s[20:23], s45 offen offset:1024 lds
  v_mfma_f32_16x16x32_bf16 v[108:111], v[16:19], v[68:71], v[108:111]
  ds_read_b128 v[36:39], v228 offset:43008
  v_mfma_f32_16x16x32_bf16 v[112:115], v[16:19], v[72:75], v[112:115]
  ds_read_b128 v[40:43], v228 offset:45056
  buffer_load_dwordx4 v244, s[20:23], s45 offen offset:2048 lds
  v_mfma_f32_16x16x32_bf16 v[116:119], v[16:19], v[76:79], v[116:119]
  ds_read_b128 v[44:47], v228 offset:47104
  v_mfma_f32_16x16x32_bf16 v[120:123], v[20:23], v[56:59], v[120:123]
  ds_read_b128 v[48:51], v228 offset:49152
  v_mfma_f32_16x16x32_bf16 v[124:127], v[20:23], v[60:63], v[124:127]
  ds_read_b128 v[52:55], v228 offset:51200
  buffer_load_dwordx4 v245, s[20:23], s45 offen offset:3072 lds
  v_mfma_f32_16x16x32_bf16 v[128:131], v[20:23], v[64:67], v[128:131]
  ds_read_b64_tr_b16 v[4:5], v232 offset:40968
  v_mfma_f32_16x16x32_bf16 v[132:135], v[20:23], v[68:71], v[132:135]
  ds_read_b64_tr_b16 v[6:7], v232 offset:41992
  s_lshl_b32 s44, s56, 7
  s_add_u32 m0, s51, 0
  s_add_u32 s44, s44, s54
  buffer_load_dwordx4 v236, s[16:19], s44 offen offset:0 lds
  v_mfma_f32_16x16x32_bf16 v[136:139], v[20:23], v[72:75], v[136:139]
  ds_read_b64_tr_b16 v[8:9], v233 offset:40960
  v_mfma_f32_16x16x32_bf16 v[140:143], v[20:23], v[76:79], v[140:143]
  ds_read_b64_tr_b16 v[10:11], v233 offset:41984
  v_mfma_f32_16x16x32_bf16 v[144:147], v[24:27], v[56:59], v[144:147]
  ds_read_b64_tr_b16 v[12:13], v233 offset:40968
  buffer_load_dwordx4 v237, s[16:19], s44 offen offset:1024 lds
  v_mfma_f32_16x16x32_bf16 v[148:151], v[24:27], v[60:63], v[148:151]
  ds_read_b64_tr_b16 v[14:15], v233 offset:41992
  v_mfma_f32_16x16x32_bf16 v[152:155], v[24:27], v[64:67], v[152:155]
  buffer_load_dwordx4 v238, s[16:19], s44 offen offset:2048 lds
  v_mfma_f32_16x16x32_bf16 v[156:159], v[24:27], v[68:71], v[156:159]
  v_mfma_f32_16x16x32_bf16 v[160:163], v[24:27], v[72:75], v[160:163]
  buffer_load_dwordx4 v239, s[16:19], s44 offen offset:3072 lds
  v_mfma_f32_16x16x32_bf16 v[164:167], v[24:27], v[76:79], v[164:167]
  v_mfma_f32_16x16x32_bf16 v[168:171], v[28:31], v[56:59], v[168:171]
  v_mfma_f32_16x16x32_bf16 v[172:175], v[28:31], v[60:63], v[172:175]
  s_add_u32 m0, s51, 4096
  s_nop 0
  buffer_load_dwordx4 v240, s[16:19], s44 offen offset:0 lds
  v_mfma_f32_16x16x32_bf16 v[176:179], v[28:31], v[64:67], v[176:179]
  v_mfma_f32_16x16x32_bf16 v[180:183], v[28:31], v[68:71], v[180:183]
  buffer_load_dwordx4 v241, s[16:19], s44 offen offset:1024 lds
  v_mfma_f32_16x16x32_bf16 v[184:187], v[28:31], v[72:75], v[184:187]
  v_mfma_f32_16x16x32_bf16 v[188:191], v[28:31], v[76:79], v[188:191]
  s_waitcnt lgkmcnt(0)
  v_mfma_f32_16x16x32_bf16 v[96:99], v[0:3], v[32:35], v[96:99]
  ds_read_b64_tr_b16 v[16:17], v232 offset:49152
  v_mfma_f32_16x16x32_bf16 v[100:103], v[0:3], v[36:39], v[100:103]
  ds_read_b64_tr_b16 v[18:19], v232 offset:50176
  v_mfma_f32_16x16x32_bf16 v[104:107], v[0:3], v[40:43], v[104:107]
  ds_read_b128 v[56:59], v229 offset:40960
  v_mfma_f32_16x16x32_bf16 v[108:111], v[0:3], v[44:47], v[108:111]
  ds_read_b128 v[60:63], v229 offset:43008
  v_mfma_f32_16x16x32_bf16 v[112:115], v[0:3], v[48:51], v[112:115]
  ds_read_b128 v[64:67], v229 offset:45056
  v_mfma_f32_16x16x32_bf16 v[116:119], v[0:3], v[52:55], v[116:119]
  ds_read_b128 v[68:71], v229 offset:47104
  v_mfma_f32_16x16x32_bf16 v[120:123], v[4:7], v[32:35], v[120:123]
  ds_read_b128 v[72:75], v229 offset:49152
  v_mfma_f32_16x16x32_bf16 v[124:127], v[4:7], v[36:39], v[124:127]
  ds_read_b128 v[76:79], v229 offset:51200
  v_mfma_f32_16x16x32_bf16 v[128:131], v[4:7], v[40:43], v[128:131]
  ds_read_b64_tr_b16 v[20:21], v232 offset:49160
  v_mfma_f32_16x16x32_bf16 v[132:135], v[4:7], v[44:47], v[132:135]
  ds_read_b64_tr_b16 v[22:23], v232 offset:50184
  v_accvgpr_write_b32 a49, 0
  v_mfma_f32_16x16x32_bf16 v[136:139], v[4:7], v[48:51], v[136:139]
  ds_read_b64_tr_b16 v[24:25], v233 offset:49152
  v_accvgpr_write_b32 a48, 0
  v_mfma_f32_16x16x32_bf16 v[140:143], v[4:7], v[52:55], v[140:143]
  ds_read_b64_tr_b16 v[26:27], v233 offset:50176
  v_accvgpr_write_b32 a47, 0
  v_mfma_f32_16x16x32_bf16 v[144:147], v[8:11], v[32:35], v[144:147]
  ds_read_b64_tr_b16 v[28:29], v233 offset:49160
  v_accvgpr_write_b32 a46, 0
  v_mfma_f32_16x16x32_bf16 v[148:151], v[8:11], v[36:39], v[148:151]
  ds_read_b64_tr_b16 v[30:31], v233 offset:50184
  v_accvgpr_write_b32 a45, 0
  v_mfma_f32_16x16x32_bf16 v[152:155], v[8:11], v[40:43], v[152:155]
  v_accvgpr_write_b32 a34, 0
  v_accvgpr_write_b32 a44, 0
  v_mfma_f32_16x16x32_bf16 v[156:159], v[8:11], v[44:47], v[156:159]
  v_accvgpr_write_b32 a33, 0
  v_accvgpr_write_b32 a43, 0
  v_mfma_f32_16x16x32_bf16 v[160:163], v[8:11], v[48:51], v[160:163]
  v_accvgpr_write_b32 a32, 0
  v_accvgpr_write_b32 a42, 0
  v_mfma_f32_16x16x32_bf16 v[164:167], v[8:11], v[52:55], v[164:167]
  v_accvgpr_write_b32 a31, 0
  v_accvgpr_write_b32 a41, 0
  v_mfma_f32_16x16x32_bf16 v[168:171], v[12:15], v[32:35], v[168:171]
  v_accvgpr_write_b32 a30, 0
  v_accvgpr_write_b32 a40, 0
  v_mfma_f32_16x16x32_bf16 v[172:175], v[12:15], v[36:39], v[172:175]
  v_accvgpr_write_b32 a29, 0
  v_accvgpr_write_b32 a39, 0
  v_mfma_f32_16x16x32_bf16 v[176:179], v[12:15], v[40:43], v[176:179]
  v_accvgpr_write_b32 a28, 0
  v_accvgpr_write_b32 a38, 0
  v_mfma_f32_16x16x32_bf16 v[180:183], v[12:15], v[44:47], v[180:183]
  v_accvgpr_write_b32 a27, 0
  v_accvgpr_write_b32 a37, 0
  v_mfma_f32_16x16x32_bf16 v[184:187], v[12:15], v[48:51], v[184:187]
  v_accvgpr_write_b32 a26, 0
  v_accvgpr_write_b32 a36, 0
  v_mfma_f32_16x16x32_bf16 v[188:191], v[12:15], v[52:55], v[188:191]
  v_accvgpr_write_b32 a25, 0
  v_accvgpr_write_b32 a35, 0
  s_waitcnt lgkmcnt(0)
  s_waitcnt vmcnt(10)
  s_barrier
  v_mfma_f32_16x16x32_bf16 v[96:99], v[16:19], v[56:59], v[96:99]
  ds_read_b64_tr_b16 v[0:1], v234 offset:0
  s_add_u32 s56, s56, 1
  s_cmp_eq_u32 s56, 9
  s_cselect_b32 s56, 0, s56
  s_lshl_b32 s45, s56, 19
  s_add_u32 m0, s50, 40960
  s_add_u32 s45, s45, s55
  buffer_load_dwordx4 v242, s[20:23], s45 offen offset:0 lds
  v_mfma_f32_16x16x32_bf16 v[100:103], v[16:19], v[60:63], v[100:103]
  ds_read_b64_tr_b16 v[2:3], v234 offset:1024
  v_mfma_f32_16x16x32_bf16 v[104:107], v[16:19], v[64:67], v[104:107]
  ds_read_b128 v[32:35], v230 offset:0
  buffer_load_dwordx4 v243, s[20:23], s45 offen offset:1024 lds
  v_mfma_f32_16x16x32_bf16 v[108:111], v[16:19], v[68:71], v[108:111]
  ds_read_b128 v[36:39], v230 offset:2048
  v_mfma_f32_16x16x32_bf16 v[112:115], v[16:19], v[72:75], v[112:115]
  ds_read_b128 v[40:43], v230 offset:4096
  buffer_load_dwordx4 v244, s[20:23], s45 offen offset:2048 lds
  v_mfma_f32_16x16x32_bf16 v[116:119], v[16:19], v[76:79], v[116:119]
  ds_read_b128 v[44:47], v230 offset:6144
  v_mfma_f32_16x16x32_bf16 v[120:123], v[20:23], v[56:59], v[120:123]
  ds_read_b128 v[48:51], v230 offset:8192
  v_mfma_f32_16x16x32_bf16 v[124:127], v[20:23], v[60:63], v[124:127]
  ds_read_b128 v[52:55], v230 offset:10240
  buffer_load_dwordx4 v245, s[20:23], s45 offen offset:3072 lds
  v_mfma_f32_16x16x32_bf16 v[128:131], v[20:23], v[64:67], v[128:131]
  ds_read_b64_tr_b16 v[4:5], v234 offset:8
  v_mfma_f32_16x16x32_bf16 v[132:135], v[20:23], v[68:71], v[132:135]
  ds_read_b64_tr_b16 v[6:7], v234 offset:1032
  s_lshl_b32 s44, s56, 7
  s_add_u32 m0, s51, 40960
  s_add_u32 s44, s44, s54
  buffer_load_dwordx4 v236, s[16:19], s44 offen offset:0 lds
  v_mfma_f32_16x16x32_bf16 v[136:139], v[20:23], v[72:75], v[136:139]
  ds_read_b64_tr_b16 v[8:9], v235 offset:0
  v_mfma_f32_16x16x32_bf16 v[140:143], v[20:23], v[76:79], v[140:143]
  ds_read_b64_tr_b16 v[10:11], v235 offset:1024
  v_mfma_f32_16x16x32_bf16 v[144:147], v[24:27], v[56:59], v[144:147]
  ds_read_b64_tr_b16 v[12:13], v235 offset:8
  buffer_load_dwordx4 v237, s[16:19], s44 offen offset:1024 lds
  v_mfma_f32_16x16x32_bf16 v[148:151], v[24:27], v[60:63], v[148:151]
  ds_read_b64_tr_b16 v[14:15], v235 offset:1032
  v_mfma_f32_16x16x32_bf16 v[152:155], v[24:27], v[64:67], v[152:155]
  buffer_load_dwordx4 v238, s[16:19], s44 offen offset:2048 lds
  v_mfma_f32_16x16x32_bf16 v[156:159], v[24:27], v[68:71], v[156:159]
  v_mfma_f32_16x16x32_bf16 v[160:163], v[24:27], v[72:75], v[160:163]
  buffer_load_dwordx4 v239, s[16:19], s44 offen offset:3072 lds
  v_mfma_f32_16x16x32_bf16 v[164:167], v[24:27], v[76:79], v[164:167]
  v_mfma_f32_16x16x32_bf16 v[168:171], v[28:31], v[56:59], v[168:171]
  v_mfma_f32_16x16x32_bf16 v[172:175], v[28:31], v[60:63], v[172:175]
  s_add_u32 m0, s51, 45056
  s_nop 0
  buffer_load_dwordx4 v240, s[16:19], s44 offen offset:0 lds
  v_mfma_f32_16x16x32_bf16 v[176:179], v[28:31], v[64:67], v[176:179]
  v_mfma_f32_16x16x32_bf16 v[180:183], v[28:31], v[68:71], v[180:183]
  buffer_load_dwordx4 v241, s[16:19], s44 offen offset:1024 lds
  v_mfma_f32_16x16x32_bf16 v[184:187], v[28:31], v[72:75], v[184:187]
  v_mfma_f32_16x16x32_bf16 v[188:191], v[28:31], v[76:79], v[188:191]
  s_waitcnt lgkmcnt(0)
  v_mfma_f32_16x16x32_bf16 v[96:99], v[0:3], v[32:35], v[96:99]
  ds_read_b64_tr_b16 v[16:17], v234 offset:8192
  v_mfma_f32_16x16x32_bf16 v[100:103], v[0:3], v[36:39], v[100:103]
  ds_read_b64_tr_b16 v[18:19], v234 offset:9216
  v_mfma_f32_16x16x32_bf16 v[104:107], v[0:3], v[40:43], v[104:107]
  ds_read_b128 v[56:59], v231 offset:0
  v_mfma_f32_16x16x32_bf16 v[108:111], v[0:3], v[44:47], v[108:111]
  ds_read_b128 v[60:63], v231 offset:2048
  v_mfma_f32_16x16x32_bf16 v[112:115], v[0:3], v[48:51], v[112:115]
  ds_read_b128 v[64:67], v231 offset:4096
  v_mfma_f32_16x16x32_bf16 v[116:119], v[0:3], v[52:55], v[116:119]
  ds_read_b128 v[68:71], v231 offset:6144
  v_mfma_f32_16x16x32_bf16 v[120:123], v[4:7], v[32:35], v[120:123]
  ds_read_b128 v[72:75], v231 offset:8192
  v_mfma_f32_16x16x32_bf16 v[124:127], v[4:7], v[36:39], v[124:127]
  ds_read_b128 v[76:79], v231 offset:10240
  v_mfma_f32_16x16x32_bf16 v[128:131], v[4:7], v[40:43], v[128:131]
  ds_read_b64_tr_b16 v[20:21], v234 offset:8200
  v_mfma_f32_16x16x32_bf16 v[132:135], v[4:7], v[44:47], v[132:135]
  ds_read_b64_tr_b16 v[22:23], v234 offset:9224
  v_accvgpr_write_b32 a74, 0
  v_mfma_f32_16x16x32_bf16 v[136:139], v[4:7], v[48:51], v[136:139]
  ds_read_b64_tr_b16 v[24:25], v235 offset:8192
  v_accvgpr_write_b32 a73, 0
  v_mfma_f32_16x16x32_bf16 v[140:143], v[4:7], v[52:55], v[140:143]
  ds_read_b64_tr_b16 v[26:27], v235 offset:9216
  v_accvgpr_write_b32 a72, 0
  v_mfma_f32_16x16x32_bf16 v[144:147], v[8:11], v[32:35], v[144:147]
  ds_read_b64_tr_b16 v[28:29], v235 offset:8200
  v_accvgpr_write_b32 a71, 0
  v_mfma_f32_16x16x32_bf16 v[148:151], v[8:11], v[36:39], v[148:151]
  ds_read_b64_tr_b16 v[30:31], v235 offset:9224
  v_accvgpr_write_b32 a70, 0
  v_mfma_f32_16x16x32_bf16 v[152:155], v[8:11], v[40:43], v[152:155]
  v_accvgpr_write_b32 a59, 0
  v_accvgpr_write_b32 a69, 0
  v_mfma_f32_16x16x32_bf16 v[156:159], v[8:11], v[44:47], v[156:159]
  v_accvgpr_write_b32 a58, 0
  v_accvgpr_write_b32 a68, 0
  v_mfma_f32_16x16x32_bf16 v[160:163], v[8:11], v[48:51], v[160:163]
  v_accvgpr_write_b32 a57, 0
  v_accvgpr_write_b32 a67, 0
  v_mfma_f32_16x16x32_bf16 v[164:167], v[8:11], v[52:55], v[164:167]
  v_accvgpr_write_b32 a56, 0
  v_accvgpr_write_b32 a66, 0
  v_mfma_f32_16x16x32_bf16 v[168:171], v[12:15], v[32:35], v[168:171]
  v_accvgpr_write_b32 a55, 0
  v_accvgpr_write_b32 a65, 0
  v_mfma_f32_16x16x32_bf16 v[172:175], v[12:15], v[36:39], v[172:175]
  v_accvgpr_write_b32 a54, 0
  v_accvgpr_write_b32 a64, 0
  v_mfma_f32_16x16x32_bf16 v[176:179], v[12:15], v[40:43], v[176:179]
  v_accvgpr_write_b32 a53, 0
  v_accvgpr_write_b32 a63, 0
  v_mfma_f32_16x16x32_bf16 v[180:183], v[12:15], v[44:47], v[180:183]
  v_accvgpr_write_b32 a52, 0
  v_accvgpr_write_b32 a62, 0
  v_mfma_f32_16x16x32_bf16 v[184:187], v[12:15], v[48:51], v[184:187]
  v_accvgpr_write_b32 a51, 0
  v_accvgpr_write_b32 a61, 0
  v_mfma_f32_16x16x32_bf16 v[188:191], v[12:15], v[52:55], v[188:191]
  v_accvgpr_write_b32 a50, 0
  v_accvgpr_write_b32 a60, 0
  s_waitcnt lgkmcnt(0)
  s_waitcnt vmcnt(10)
  s_barrier
  v_mfma_f32_16x16x32_bf16 v[96:99], v[16:19], v[56:59], v[96:99]
  ds_read_b64_tr_b16 v[0:1], v232 offset:0
  s_add_u32 s56, s56, 1
  s_cmp_eq_u32 s56, 9
  s_cselect_b32 s56, 0, s56
  s_lshl_b32 s45, s56, 19
  s_add_u32 m0, s50, 114688
  s_add_u32 s45, s45, s55
  buffer_load_dwordx4 v242, s[20:23], s45 offen offset:0 lds
  v_mfma_f32_16x16x32_bf16 v[100:103], v[16:19], v[60:63], v[100:103]
  ds_read_b64_tr_b16 v[2:3], v232 offset:1024
  v_mfma_f32_16x16x32_bf16 v[104:107], v[16:19], v[64:67], v[104:107]
  ds_read_b128 v[32:35], v228 offset:0
  buffer_load_dwordx4 v243, s[20:23], s45 offen offset:1024 lds
  v_mfma_f32_16x16x32_bf16 v[108:111], v[16:19], v[68:71], v[108:111]
  ds_read_b128 v[36:39], v228 offset:2048
  v_mfma_f32_16x16x32_bf16 v[112:115], v[16:19], v[72:75], v[112:115]
  ds_read_b128 v[40:43], v228 offset:4096
  buffer_load_dwordx4 v244, s[20:23], s45 offen offset:2048 lds
  v_mfma_f32_16x16x32_bf16 v[116:119], v[16:19], v[76:79], v[116:119]
  ds_read_b128 v[44:47], v228 offset:6144
  v_mfma_f32_16x16x32_bf16 v[120:123], v[20:23], v[56:59], v[120:123]
  ds_read_b128 v[48:51], v228 offset:8192
  v_mfma_f32_16x16x32_bf16 v[124:127], v[20:23], v[60:63], v[124:127]
  ds_read_b128 v[52:55], v228 offset:10240
  buffer_load_dwordx4 v245, s[20:23], s45 offen offset:3072 lds
  v_mfma_f32_16x16x32_bf16 v[128:131], v[20:23], v[64:67], v[128:131]
  ds_read_b64_tr_b16 v[4:5], v232 offset:8
  v_mfma_f32_16x16x32_bf16 v[132:135], v[20:23], v[68:71], v[132:135]
  ds_read_b64_tr_b16 v[6:7], v232 offset:1032
  s_lshl_b32 s44, s56, 7
  s_add_u32 m0, s51, 114688
  s_add_u32 s44, s44, s54
  buffer_load_dwordx4 v236, s[16:19], s44 offen offset:0 lds
  v_mfma_f32_16x16x32_bf16 v[136:139], v[20:23], v[72:75], v[136:139]
  ds_read_b64_tr_b16 v[8:9], v233 offset:0
  v_mfma_f32_16x16x32_bf16 v[140:143], v[20:23], v[76:79], v[140:143]
  ds_read_b64_tr_b16 v[10:11], v233 offset:1024
  v_mfma_f32_16x16x32_bf16 v[144:147], v[24:27], v[56:59], v[144:147]
  ds_read_b64_tr_b16 v[12:13], v233 offset:8
  buffer_load_dwordx4 v237, s[16:19], s44 offen offset:1024 lds
  v_mfma_f32_16x16x32_bf16 v[148:151], v[24:27], v[60:63], v[148:151]
  ds_read_b64_tr_b16 v[14:15], v233 offset:1032
  v_mfma_f32_16x16x32_bf16 v[152:155], v[24:27], v[64:67], v[152:155]
  buffer_load_dwordx4 v238, s[16:19], s44 offen offset:2048 lds
  v_mfma_f32_16x16x32_bf16 v[156:159], v[24:27], v[68:71], v[156:159]
  v_mfma_f32_16x16x32_bf16 v[160:163], v[24:27], v[72:75], v[160:163]
  buffer_load_dwordx4 v239, s[16:19], s44 offen offset:3072 lds
  v_mfma_f32_16x16x32_bf16 v[164:167], v[24:27], v[76:79], v[164:167]
  v_mfma_f32_16x16x32_bf16 v[168:171], v[28:31], v[56:59], v[168:171]
  v_mfma_f32_16x16x32_bf16 v[172:175], v[28:31], v[60:63], v[172:175]
  s_add_u32 m0, s51, 118784
  s_nop 0
  buffer_load_dwordx4 v240, s[16:19], s44 offen offset:0 lds
  v_mfma_f32_16x16x32_bf16 v[176:179], v[28:31], v[64:67], v[176:179]
  v_mfma_f32_16x16x32_bf16 v[180:183], v[28:31], v[68:71], v[180:183]
  buffer_load_dwordx4 v241, s[16:19], s44 offen offset:1024 lds
  v_mfma_f32_16x16x32_bf16 v[184:187], v[28:31], v[72:75], v[184:187]
  v_mfma_f32_16x16x32_bf16 v[188:191], v[28:31], v[76:79], v[188:191]
  s_waitcnt lgkmcnt(0)
  v_mfma_f32_16x16x32_bf16 v[96:99], v[0:3], v[32:35], v[96:99]
  ds_read_b64_tr_b16 v[16:17], v232 offset:8192
  v_mfma_f32_16x16x32_bf16 v[100:103], v[0:3], v[36:39], v[100:103]
  ds_read_b64_tr_b16 v[18:19], v232 offset:9216
  v_mfma_f32_16x16x32_bf16 v[104:107], v[0:3], v[40:43], v[104:107]
  ds_read_b128 v[56:59], v229 offset:0
  v_mfma_f32_16x16x32_bf16 v[108:111], v[0:3], v[44:47], v[108:111]
  ds_read_b128 v[60:63], v229 offset:2048
  v_mfma_f32_16x16x32_bf16 v[112:115], v[0:3], v[48:51], v[112:115]
  ds_read_b128 v[64:67], v229 offset:4096
  v_mfma_f32_16x16x32_bf16 v[116:119], v[0:3], v[52:55], v[116:119]
  ds_read_b128 v[68:71], v229 offset:6144
  v_mfma_f32_16x16x32_bf16 v[120:123], v[4:7], v[32:35], v[120:123]
  ds_read_b128 v[72:75], v229 offset:8192
  v_mfma_f32_16x16x32_bf16 v[124:127], v[4:7], v[36:39], v[124:127]
  ds_read_b128 v[76:79], v229 offset:10240
  v_mfma_f32_16x16x32_bf16 v[128:131], v[4:7], v[40:43], v[128:131]
  ds_read_b64_tr_b16 v[20:21], v232 offset:8200
  v_mfma_f32_16x16x32_bf16 v[132:135], v[4:7], v[44:47], v[132:135]
  ds_read_b64_tr_b16 v[22:23], v232 offset:9224
  v_accvgpr_write_b32 a99, 0
  v_mfma_f32_16x16x32_bf16 v[136:139], v[4:7], v[48:51], v[136:139]
  ds_read_b64_tr_b16 v[24:25], v233 offset:8192
  v_accvgpr_write_b32 a98, 0
  v_mfma_f32_16x16x32_bf16 v[140:143], v[4:7], v[52:55], v[140:143]
  ds_read_b64_tr_b16 v[26:27], v233 offset:9216
  v_accvgpr_write_b32 a97, 0
  v_mfma_f32_16x16x32_bf16 v[144:147], v[8:11], v[32:35], v[144:147]
  ds_read_b64_tr_b16 v[28:29], v233 offset:8200
  v_accvgpr_write_b32 a96, 0
  v_mfma_f32_16x16x32_bf16 v[148:151], v[8:11], v[36:39], v[148:151]
  ds_read_b64_tr_b16 v[30:31], v233 offset:9224
  v_accvgpr_write_b32 a95, 0
  v_mfma_f32_16x16x32_bf16 v[152:155], v[8:11], v[40:43], v[152:155]
  v_accvgpr_write_b32 a84, 0
  v_accvgpr_write_b32 a94, 0
  v_mfma_f32_16x16x32_bf16 v[156:159], v[8:11], v[44:47], v[156:159]
  v_accvgpr_write_b32 a83, 0
  v_accvgpr_write_b32 a93, 0
  v_mfma_f32_16x16x32_bf16 v[160:163], v[8:11], v[48:51], v[160:163]
  v_accvgpr_write_b32 a82, 0
  v_accvgpr_write_b32 a92, 0
  v_mfma_f32_16x16x32_bf16 v[164:167], v[8:11], v[52:55], v[164:167]
  v_accvgpr_write_b32 a81, 0
  v_accvgpr_write_b32 a91, 0
  v_mfma_f32_16x16x32_bf16 v[168:171], v[12:15], v[32:35], v[168:171]
  v_accvgpr_write_b32 a80, 0
  v_accvgpr_write_b32 a90, 0
  v_mfma_f32_16x16x32_bf16 v[172:175], v[12:15], v[36:39], v[172:175]
  v_accvgpr_write_b32 a79, 0
  v_accvgpr_write_b32 a89, 0
  v_mfma_f32_16x16x32_bf16 v[176:179], v[12:15], v[40:43], v[176:179]
  v_accvgpr_write_b32 a78, 0
  v_accvgpr_write_b32 a88, 0
  v_mfma_f32_16x16x32_bf16 v[180:183], v[12:15], v[44:47], v[180:183]
  v_accvgpr_write_b32 a77, 0
  v_accvgpr_write_b32 a87, 0
  v_mfma_f32_16x16x32_bf16 v[184:187], v[12:15], v[48:51], v[184:187]
  v_accvgpr_write_b32 a76, 0
  v_accvgpr_write_b32 a86, 0
  v_mfma_f32_16x16x32_bf16 v[188:191], v[12:15], v[52:55], v[188:191]
  v_accvgpr_write_b32 a75, 0
  v_accvgpr_write_b32 a85, 0
  s_waitcnt lgkmcnt(0)
  s_waitcnt vmcnt(10)
  s_barrier
  v_mfma_f32_16x16x32_bf16 v[96:99], v[16:19], v[56:59], v[96:99]
  ds_read_b64_tr_b16 v[0:1], v232 offset:40960
  s_add_u32 s56, s56, 1
  s_cmp_eq_u32 s56, 9
  s_cselect_b32 s56, 0, s56
  s_lshl_b32 s45, s56, 19
  s_add_u32 m0, s50, 0
  s_add_u32 s45, s45, s55
  buffer_load_dwordx4 v242, s[20:23], s45 offen offset:0 lds
  v_mfma_f32_16x16x32_bf16 v[100:103], v[16:19], v[60:63], v[100:103]
  ds_read_b64_tr_b16 v[2:3], v232 offset:41984
  v_mfma_f32_16x16x32_bf16 v[104:107], v[16:19], v[64:67], v[104:107]
  ds_read_b128 v[32:35], v228 offset:40960
  buffer_load_dwordx4 v243, s[20:23], s45 offen offset:1024 lds
  v_mfma_f32_16x16x32_bf16 v[108:111], v[16:19], v[68:71], v[108:111]
  ds_read_b128 v[36:39], v228 offset:43008
  v_mfma_f32_16x16x32_bf16 v[112:115], v[16:19], v[72:75], v[112:115]
  ds_read_b128 v[40:43], v228 offset:45056
  buffer_load_dwordx4 v244, s[20:23], s45 offen offset:2048 lds
  v_mfma_f32_16x16x32_bf16 v[116:119], v[16:19], v[76:79], v[116:119]
  ds_read_b128 v[44:47], v228 offset:47104
  v_mfma_f32_16x16x32_bf16 v[120:123], v[20:23], v[56:59], v[120:123]
  ds_read_b128 v[48:51], v228 offset:49152
  v_mfma_f32_16x16x32_bf16 v[124:127], v[20:23], v[60:63], v[124:127]
  ds_read_b128 v[52:55], v228 offset:51200
  buffer_load_dwordx4 v245, s[20:23], s45 offen offset:3072 lds
  v_mfma_f32_16x16x32_bf16 v[128:131], v[20:23], v[64:67], v[128:131]
  ds_read_b64_tr_b16 v[4:5], v232 offset:40968
  v_mfma_f32_16x16x32_bf16 v[132:135], v[20:23], v[68:71], v[132:135]
  ds_read_b64_tr_b16 v[6:7], v232 offset:41992
  s_lshl_b32 s44, s56, 7
  s_add_u32 m0, s51, 0
  s_add_u32 s44, s44, s54
  buffer_load_dwordx4 v236, s[16:19], s44 offen offset:0 lds
  v_mfma_f32_16x16x32_bf16 v[136:139], v[20:23], v[72:75], v[136:139]
  ds_read_b64_tr_b16 v[8:9], v233 offset:40960
  v_mfma_f32_16x16x32_bf16 v[140:143], v[20:23], v[76:79], v[140:143]
  ds_read_b64_tr_b16 v[10:11], v233 offset:41984
  v_mfma_f32_16x16x32_bf16 v[144:147], v[24:27], v[56:59], v[144:147]
  ds_read_b64_tr_b16 v[12:13], v233 offset:40968
  buffer_load_dwordx4 v237, s[16:19], s44 offen offset:1024 lds
  v_mfma_f32_16x16x32_bf16 v[148:151], v[24:27], v[60:63], v[148:151]
  ds_read_b64_tr_b16 v[14:15], v233 offset:41992
  v_mfma_f32_16x16x32_bf16 v[152:155], v[24:27], v[64:67], v[152:155]
  buffer_load_dwordx4 v238, s[16:19], s44 offen offset:2048 lds
  v_mfma_f32_16x16x32_bf16 v[156:159], v[24:27], v[68:71], v[156:159]
  v_mfma_f32_16x16x32_bf16 v[160:163], v[24:27], v[72:75], v[160:163]
  buffer_load_dwordx4 v239, s[16:19], s44 offen offset:3072 lds
  v_mfma_f32_16x16x32_bf16 v[164:167], v[24:27], v[76:79], v[164:167]
  v_mfma_f32_16x16x32_bf16 v[168:171], v[28:31], v[56:59], v[168:171]
  v_mfma_f32_16x16x32_bf16 v[172:175], v[28:31], v[60:63], v[172:175]
  s_add_u32 m0, s51, 4096
  s_nop 0
  buffer_load_dwordx4 v240, s[16:19], s44 offen offset:0 lds
  v_mfma_f32_16x16x32_bf16 v[176:179], v[28:31], v[64:67], v[176:179]
  v_mfma_f32_16x16x32_bf16 v[180:183], v[28:31], v[68:71], v[180:183]
  buffer_load_dwordx4 v241, s[16:19], s44 offen offset:1024 lds
  v_mfma_f32_16x16x32_bf16 v[184:187], v[28:31], v[72:75], v[184:187]
  v_mfma_f32_16x16x32_bf16 v[188:191], v[28:31], v[76:79], v[188:191]
  s_waitcnt lgkmcnt(0)
  v_mfma_f32_16x16x32_bf16 v[96:99], v[0:3], v[32:35], v[96:99]
  ds_read_b64_tr_b16 v[16:17], v232 offset:49152
  v_mfma_f32_16x16x32_bf16 v[100:103], v[0:3], v[36:39], v[100:103]
  ds_read_b64_tr_b16 v[18:19], v232 offset:50176
  v_mfma_f32_16x16x32_bf16 v[104:107], v[0:3], v[40:43], v[104:107]
  ds_read_b128 v[56:59], v229 offset:40960
  v_mfma_f32_16x16x32_bf16 v[108:111], v[0:3], v[44:47], v[108:111]
  ds_read_b128 v[60:63], v229 offset:43008
  v_mfma_f32_16x16x32_bf16 v[112:115], v[0:3], v[48:51], v[112:115]
  ds_read_b128 v[64:67], v229 offset:45056
  v_mfma_f32_16x16x32_bf16 v[116:119], v[0:3], v[52:55], v[116:119]
  ds_read_b128 v[68:71], v229 offset:47104
  v_mfma_f32_16x16x32_bf16 v[120:123], v[4:7], v[32:35], v[120:123]
  ds_read_b128 v[72:75], v229 offset:49152
  v_mfma_f32_16x16x32_bf16 v[124:127], v[4:7], v[36:39], v[124:127]
  ds_read_b128 v[76:79], v229 offset:51200
  v_mfma_f32_16x16x32_bf16 v[128:131], v[4:7], v[40:43], v[128:131]
  ds_read_b64_tr_b16 v[20:21], v232 offset:49160
  v_mfma_f32_16x16x32_bf16 v[132:135], v[4:7], v[44:47], v[132:135]
  ds_read_b64_tr_b16 v[22:23], v232 offset:50184
  v_accvgpr_write_b32 a124, 0
  v_mfma_f32_16x16x32_bf16 v[136:139], v[4:7], v[48:51], v[136:139]
  ds_read_b64_tr_b16 v[24:25], v233 offset:49152
  v_accvgpr_write_b32 a123, 0
  v_mfma_f32_16x16x32_bf16 v[140:143], v[4:7], v[52:55], v[140:143]
  ds_read_b64_tr_b16 v[26:27], v233 offset:50176
  v_accvgpr_write_b32 a122, 0
  v_mfma_f32_16x16x32_bf16 v[144:147], v[8:11], v[32:35], v[144:147]
  ds_read_b64_tr_b16 v[28:29], v233 offset:49160
  v_accvgpr_write_b32 a121, 0
  v_mfma_f32_16x16x32_bf16 v[148:151], v[8:11], v[36:39], v[148:151]
  ds_read_b64_tr_b16 v[30:31], v233 offset:50184
  v_accvgpr_write_b32 a120, 0
  v_mfma_f32_16x16x32_bf16 v[152:155], v[8:11], v[40:43], v[152:155]
  v_accvgpr_write_b32 a109, 0
  v_accvgpr_write_b32 a119, 0
  v_mfma_f32_16x16x32_bf16 v[156:159], v[8:11], v[44:47], v[156:159]
  v_accvgpr_write_b32 a108, 0
  v_accvgpr_write_b32 a118, 0
  v_mfma_f32_16x16x32_bf16 v[160:163], v[8:11], v[48:51], v[160:163]
  v_accvgpr_write_b32 a107, 0
  v_accvgpr_write_b32 a117, 0
  v_mfma_f32_16x16x32_bf16 v[164:167], v[8:11], v[52:55], v[164:167]
  v_accvgpr_write_b32 a106, 0
  v_accvgpr_write_b32 a116, 0
  v_mfma_f32_16x16x32_bf16 v[168:171], v[12:15], v[32:35], v[168:171]
  v_accvgpr_write_b32 a105, 0
  v_accvgpr_write_b32 a115, 0
  v_mfma_f32_16x16x32_bf16 v[172:175], v[12:15], v[36:39], v[172:175]
  v_accvgpr_write_b32 a104, 0
  v_accvgpr_write_b32 a114, 0
  v_mfma_f32_16x16x32_bf16 v[176:179], v[12:15], v[40:43], v[176:179]
  v_accvgpr_write_b32 a103, 0
  v_accvgpr_write_b32 a113, 0
  v_mfma_f32_16x16x32_bf16 v[180:183], v[12:15], v[44:47], v[180:183]
  v_accvgpr_write_b32 a102, 0
  v_accvgpr_write_b32 a112, 0
  v_mfma_f32_16x16x32_bf16 v[184:187], v[12:15], v[48:51], v[184:187]
  v_accvgpr_write_b32 a101, 0
  v_accvgpr_write_b32 a111, 0
  v_mfma_f32_16x16x32_bf16 v[188:191], v[12:15], v[52:55], v[188:191]
  v_accvgpr_write_b32 a100, 0
  v_accvgpr_write_b32 a110, 0
  s_waitcnt lgkmcnt(0)
  s_waitcnt vmcnt(10)
  s_barrier
  v_mfma_f32_16x16x32_bf16 v[96:99], v[16:19], v[56:59], v[96:99]
  ds_read_b64_tr_b16 v[0:1], v234 offset:0
  s_add_u32 s56, s56, 1
  s_cmp_eq_u32 s56, 9
  s_cselect_b32 s56, 0, s56
  s_lshl_b32 s45, s56, 19
  s_add_u32 m0, s50, 40960
  s_add_u32 s45, s45, s55
  buffer_load_dwordx4 v242, s[20:23], s45 offen offset:0 lds
  v_mfma_f32_16x16x32_bf16 v[100:103], v[16:19], v[60:63], v[100:103]
  ds_read_b64_tr_b16 v[2:3], v234 offset:1024
  v_mfma_f32_16x16x32_bf16 v[104:107], v[16:19], v[64:67], v[104:107]
  ds_read_b128 v[32:35], v230 offset:0
  buffer_load_dwordx4 v243, s[20:23], s45 offen offset:1024 lds
  v_mfma_f32_16x16x32_bf16 v[108:111], v[16:19], v[68:71], v[108:111]
  ds_read_b128 v[36:39], v230 offset:2048
  v_mfma_f32_16x16x32_bf16 v[112:115], v[16:19], v[72:75], v[112:115]
  ds_read_b128 v[40:43], v230 offset:4096
  buffer_load_dwordx4 v244, s[20:23], s45 offen offset:2048 lds
  v_mfma_f32_16x16x32_bf16 v[116:119], v[16:19], v[76:79], v[116:119]
  ds_read_b128 v[44:47], v230 offset:6144
  v_mfma_f32_16x16x32_bf16 v[120:123], v[20:23], v[56:59], v[120:123]
  ds_read_b128 v[48:51], v230 offset:8192
  v_mfma_f32_16x16x32_bf16 v[124:127], v[20:23], v[60:63], v[124:127]
  ds_read_b128 v[52:55], v230 offset:10240
  buffer_load_dwordx4 v245, s[20:23], s45 offen offset:3072 lds
  v_mfma_f32_16x16x32_bf16 v[128:131], v[20:23], v[64:67], v[128:131]
  ds_read_b64_tr_b16 v[4:5], v234 offset:8
  v_mfma_f32_16x16x32_bf16 v[132:135], v[20:23], v[68:71], v[132:135]
  ds_read_b64_tr_b16 v[6:7], v234 offset:1032
  s_lshl_b32 s44, s56, 7
  s_add_u32 m0, s51, 40960
  s_add_u32 s44, s44, s54
  buffer_load_dwordx4 v236, s[16:19], s44 offen offset:0 lds
  v_mfma_f32_16x16x32_bf16 v[136:139], v[20:23], v[72:75], v[136:139]
  ds_read_b64_tr_b16 v[8:9], v235 offset:0
  v_mfma_f32_16x16x32_bf16 v[140:143], v[20:23], v[76:79], v[140:143]
  ds_read_b64_tr_b16 v[10:11], v235 offset:1024
  v_mfma_f32_16x16x32_bf16 v[144:147], v[24:27], v[56:59], v[144:147]
  ds_read_b64_tr_b16 v[12:13], v235 offset:8
  buffer_load_dwordx4 v237, s[16:19], s44 offen offset:1024 lds
  v_mfma_f32_16x16x32_bf16 v[148:151], v[24:27], v[60:63], v[148:151]
  ds_read_b64_tr_b16 v[14:15], v235 offset:1032
  v_mfma_f32_16x16x32_bf16 v[152:155], v[24:27], v[64:67], v[152:155]
  buffer_load_dwordx4 v238, s[16:19], s44 offen offset:2048 lds
  v_mfma_f32_16x16x32_bf16 v[156:159], v[24:27], v[68:71], v[156:159]
  v_mfma_f32_16x16x32_bf16 v[160:163], v[24:27], v[72:75], v[160:163]
  buffer_load_dwordx4 v239, s[16:19], s44 offen offset:3072 lds
  v_mfma_f32_16x16x32_bf16 v[164:167], v[24:27], v[76:79], v[164:167]
  v_mfma_f32_16x16x32_bf16 v[168:171], v[28:31], v[56:59], v[168:171]
  v_mfma_f32_16x16x32_bf16 v[172:175], v[28:31], v[60:63], v[172:175]
  s_add_u32 m0, s51, 45056
  s_nop 0
  buffer_load_dwordx4 v240, s[16:19], s44 offen offset:0 lds
  v_mfma_f32_16x16x32_bf16 v[176:179], v[28:31], v[64:67], v[176:179]
  v_mfma_f32_16x16x32_bf16 v[180:183], v[28:31], v[68:71], v[180:183]
  buffer_load_dwordx4 v241, s[16:19], s44 offen offset:1024 lds
  v_mfma_f32_16x16x32_bf16 v[184:187], v[28:31], v[72:75], v[184:187]
  v_mfma_f32_16x16x32_bf16 v[188:191], v[28:31], v[76:79], v[188:191]
  s_waitcnt lgkmcnt(0)
  v_mfma_f32_16x16x32_bf16 v[96:99], v[0:3], v[32:35], v[96:99]
  ds_read_b64_tr_b16 v[16:17], v234 offset:8192
  v_mfma_f32_16x16x32_bf16 v[100:103], v[0:3], v[36:39], v[100:103]
  ds_read_b64_tr_b16 v[18:19], v234 offset:9216
  v_mfma_f32_16x16x32_bf16 v[104:107], v[0:3], v[40:43], v[104:107]
  ds_read_b128 v[56:59], v231 offset:0
  v_mfma_f32_16x16x32_bf16 v[108:111], v[0:3], v[44:47], v[108:111]
  ds_read_b128 v[60:63], v231 offset:2048
  v_mfma_f32_16x16x32_bf16 v[112:115], v[0:3], v[48:51], v[112:115]
  ds_read_b128 v[64:67], v231 offset:4096
  v_mfma_f32_16x16x32_bf16 v[116:119], v[0:3], v[52:55], v[116:119]
  ds_read_b128 v[68:71], v231 offset:6144
  v_mfma_f32_16x16x32_bf16 v[120:123], v[4:7], v[32:35], v[120:123]
  ds_read_b128 v[72:75], v231 offset:8192
  v_mfma_f32_16x16x32_bf16 v[124:127], v[4:7], v[36:39], v[124:127]
  ds_read_b128 v[76:79], v231 offset:10240
  v_mfma_f32_16x16x32_bf16 v[128:131], v[4:7], v[40:43], v[128:131]
  ds_read_b64_tr_b16 v[20:21], v234 offset:8200
  v_mfma_f32_16x16x32_bf16 v[132:135], v[4:7], v[44:47], v[132:135]
  ds_read_b64_tr_b16 v[22:23], v234 offset:9224
  v_accvgpr_write_b32 a149, 0
  v_mfma_f32_16x16x32_bf16 v[136:139], v[4:7], v[48:51], v[136:139]
  ds_read_b64_tr_b16 v[24:25], v235 offset:8192
  v_accvgpr_write_b32 a148, 0
  v_mfma_f32_16x16x32_bf16 v[140:143], v[4:7], v[52:55], v[140:143]
  ds_read_b64_tr_b16 v[26:27], v235 offset:9216
  v_accvgpr_write_b32 a147, 0
  v_mfma_f32_16x16x32_bf16 v[144:147], v[8:11], v[32:35], v[144:147]
  ds_read_b64_tr_b16 v[28:29], v235 offset:8200
  v_accvgpr_write_b32 a146, 0
  v_mfma_f32_16x16x32_bf16 v[148:151], v[8:11], v[36:39], v[148:151]
  ds_read_b64_tr_b16 v[30:31], v235 offset:9224
  v_accvgpr_write_b32 a145, 0
  v_mfma_f32_16x16x32_bf16 v[152:155], v[8:11], v[40:43], v[152:155]
  v_accvgpr_write_b32 a134, 0
  v_accvgpr_write_b32 a144, 0
  v_mfma_f32_16x16x32_bf16 v[156:159], v[8:11], v[44:47], v[156:159]
  v_accvgpr_write_b32 a133, 0
  v_accvgpr_write_b32 a143, 0
  v_mfma_f32_16x16x32_bf16 v[160:163], v[8:11], v[48:51], v[160:163]
  v_accvgpr_write_b32 a132, 0
  v_accvgpr_write_b32 a142, 0
  v_mfma_f32_16x16x32_bf16 v[164:167], v[8:11], v[52:55], v[164:167]
  v_accvgpr_write_b32 a131, 0
  v_accvgpr_write_b32 a141, 0
  v_mfma_f32_16x16x32_bf16 v[168:171], v[12:15], v[32:35], v[168:171]
  v_accvgpr_write_b32 a130, 0
  v_accvgpr_write_b32 a140, 0
  v_mfma_f32_16x16x32_bf16 v[172:175], v[12:15], v[36:39], v[172:175]
  v_accvgpr_write_b32 a129, 0
  v_accvgpr_write_b32 a139, 0
  v_mfma_f32_16x16x32_bf16 v[176:179], v[12:15], v[40:43], v[176:179]
  v_accvgpr_write_b32 a128, 0
  v_accvgpr_write_b32 a138, 0
  v_mfma_f32_16x16x32_bf16 v[180:183], v[12:15], v[44:47], v[180:183]
  v_accvgpr_write_b32 a127, 0
  v_accvgpr_write_b32 a137, 0
  v_mfma_f32_16x16x32_bf16 v[184:187], v[12:15], v[48:51], v[184:187]
  v_accvgpr_write_b32 a126, 0
  v_accvgpr_write_b32 a136, 0
  v_mfma_f32_16x16x32_bf16 v[188:191], v[12:15], v[52:55], v[188:191]
  v_accvgpr_write_b32 a125, 0
  v_accvgpr_write_b32 a135, 0
  s_waitcnt lgkmcnt(0)
  s_waitcnt vmcnt(10)
  s_barrier
  v_mfma_f32_16x16x32_bf16 v[96:99], v[16:19], v[56:59], v[96:99]
  ds_read_b64_tr_b16 v[0:1], v232 offset:0
  s_add_u32 s56, s56, 1
  s_cmp_eq_u32 s56, 9
  s_cselect_b32 s56, 0, s56
  s_lshl_b32 s45, s56, 19
  s_add_u32 m0, s50, 114688
  s_add_u32 s45, s45, s55
  buffer_load_dwordx4 v242, s[20:23], s45 offen offset:0 lds
  v_mfma_f32_16x16x32_bf16 v[100:103], v[16:19], v[60:63], v[100:103]
  ds_read_b64_tr_b16 v[2:3], v232 offset:1024
  buffer_load_dwordx4 v243, s[20:23], s45 offen offset:1024 lds
  v_mfma_f32_16x16x32_bf16 v[104:107], v[16:19], v[64:67], v[104:107]
  ds_read_b128 v[32:35], v228 offset:0
  v_mfma_f32_16x16x32_bf16 v[108:111], v[16:19], v[68:71], v[108:111]
  ds_read_b128 v[36:39], v228 offset:2048
  buffer_load_dwordx4 v244, s[20:23], s45 offen offset:2048 lds
  v_mfma_f32_16x16x32_bf16 v[112:115], v[16:19], v[72:75], v[112:115]
  ds_read_b128 v[40:43], v228 offset:4096
  v_mfma_f32_16x16x32_bf16 v[116:119], v[16:19], v[76:79], v[116:119]
  ds_read_b128 v[44:47], v228 offset:6144
  buffer_load_dwordx4 v245, s[20:23], s45 offen offset:3072 lds
  v_mfma_f32_16x16x32_bf16 v[120:123], v[20:23], v[56:59], v[120:123]
  ds_read_b128 v[48:51], v228 offset:8192
  s_lshl_b32 s44, s56, 7
  s_add_u32 m0, s51, 114688
  s_add_u32 s44, s44, s54
  buffer_load_dwordx4 v236, s[16:19], s44 offen offset:0 lds
  v_mfma_f32_16x16x32_bf16 v[124:127], v[20:23], v[60:63], v[124:127]
  ds_read_b128 v[52:55], v228 offset:10240
  v_mfma_f32_16x16x32_bf16 v[128:131], v[20:23], v[64:67], v[128:131]
  ds_read_b64_tr_b16 v[4:5], v232 offset:8
  buffer_load_dwordx4 v237, s[16:19], s44 offen offset:1024 lds
  v_mfma_f32_16x16x32_bf16 v[132:135], v[20:23], v[68:71], v[132:135]
  ds_read_b64_tr_b16 v[6:7], v232 offset:1032
  v_mfma_f32_16x16x32_bf16 v[136:139], v[20:23], v[72:75], v[136:139]
  ds_read_b64_tr_b16 v[8:9], v233 offset:0
  buffer_load_dwordx4 v238, s[16:19], s44 offen offset:2048 lds
  v_mfma_f32_16x16x32_bf16 v[140:143], v[20:23], v[76:79], v[140:143]
  ds_read_b64_tr_b16 v[10:11], v233 offset:1024
  v_mfma_f32_16x16x32_bf16 v[144:147], v[24:27], v[56:59], v[144:147]
  ds_read_b64_tr_b16 v[12:13], v233 offset:8
  buffer_load_dwordx4 v239, s[16:19], s44 offen offset:3072 lds
  v_mfma_f32_16x16x32_bf16 v[148:151], v[24:27], v[60:63], v[148:151]
  ds_read_b64_tr_b16 v[14:15], v233 offset:1032
  s_add_u32 m0, s51, 118784
  s_nop 0
  buffer_load_dwordx4 v240, s[16:19], s44 offen offset:0 lds
  v_mfma_f32_16x16x32_bf16 v[152:155], v[24:27], v[64:67], v[152:155]
  v_mfma_f32_16x16x32_bf16 v[156:159], v[24:27], v[68:71], v[156:159]
  buffer_load_dwordx4 v241, s[16:19], s44 offen offset:1024 lds
  v_mfma_f32_16x16x32_bf16 v[160:163], v[24:27], v[72:75], v[160:163]
  v_mfma_f32_16x16x32_bf16 v[164:167], v[24:27], v[76:79], v[164:167]
  s_add_u32 m0, s43, 98304
  s_add_u32 s44, s43, 0
  buffer_load_dwordx4 v220, s[8:11], s44 offen offset:0 nt lds
  v_mfma_f32_16x16x32_bf16 v[168:171], v[28:31], v[56:59], v[168:171]
  buffer_load_dwordx4 v221, s[8:11], s44 offen offset:1024 nt lds
  v_mfma_f32_16x16x32_bf16 v[172:175], v[28:31], v[60:63], v[172:175]
  v_mfma_f32_16x16x32_bf16 v[176:179], v[28:31], v[64:67], v[176:179]
  buffer_load_dwordx4 v222, s[8:11], s44 offen offset:2048 nt lds
  v_mfma_f32_16x16x32_bf16 v[180:183], v[28:31], v[68:71], v[180:183]
  v_mfma_f32_16x16x32_bf16 v[184:187], v[28:31], v[72:75], v[184:187]
  buffer_load_dwordx4 v223, s[8:11], s44 offen offset:3072 nt lds
  v_mfma_f32_16x16x32_bf16 v[188:191], v[28:31], v[76:79], v[188:191]
  s_waitcnt lgkmcnt(0)
  v_mfma_f32_16x16x32_bf16 v[96:99], v[0:3], v[32:35], v[96:99]
  ds_read_b64_tr_b16 v[16:17], v232 offset:8192
  v_mfma_f32_16x16x32_bf16 v[100:103], v[0:3], v[36:39], v[100:103]
  ds_read_b64_tr_b16 v[18:19], v232 offset:9216
  v_mfma_f32_16x16x32_bf16 v[104:107], v[0:3], v[40:43], v[104:107]
  ds_read_b128 v[56:59], v229 offset:0
  v_mfma_f32_16x16x32_bf16 v[108:111], v[0:3], v[44:47], v[108:111]
  ds_read_b128 v[60:63], v229 offset:2048
  v_mfma_f32_16x16x32_bf16 v[112:115], v[0:3], v[48:51], v[112:115]
  ds_read_b128 v[64:67], v229 offset:4096
  v_mfma_f32_16x16x32_bf16 v[116:119], v[0:3], v[52:55], v[116:119]
  ds_read_b128 v[68:71], v229 offset:6144
  v_mfma_f32_16x16x32_bf16 v[120:123], v[4:7], v[32:35], v[120:123]
  ds_read_b128 v[72:75], v229 offset:8192
  v_mfma_f32_16x16x32_bf16 v[124:127], v[4:7], v[36:39], v[124:127]
  ds_read_b128 v[76:79], v229 offset:10240
  v_mfma_f32_16x16x32_bf16 v[128:131], v[4:7], v[40:43], v[128:131]
  ds_read_b64_tr_b16 v[20:21], v232 offset:8200
  v_mfma_f32_16x16x32_bf16 v[132:135], v[4:7], v[44:47], v[132:135]
  ds_read_b64_tr_b16 v[22:23], v232 offset:9224
  v_accvgpr_write_b32 a174, 0
  v_mfma_f32_16x16x32_bf16 v[136:139], v[4:7], v[48:51], v[136:139]
  ds_read_b64_tr_b16 v[24:25], v233 offset:8192
  v_accvgpr_write_b32 a173, 0
  v_mfma_f32_16x16x32_bf16 v[140:143], v[4:7], v[52:55], v[140:143]
  ds_read_b64_tr_b16 v[26:27], v233 offset:9216
  v_accvgpr_write_b32 a172, 0
  v_mfma_f32_16x16x32_bf16 v[144:147], v[8:11], v[32:35], v[144:147]
  ds_read_b64_tr_b16 v[28:29], v233 offset:8200
  v_accvgpr_write_b32 a171, 0
  v_mfma_f32_16x16x32_bf16 v[148:151], v[8:11], v[36:39], v[148:151]
  ds_read_b64_tr_b16 v[30:31], v233 offset:9224
  v_accvgpr_write_b32 a170, 0
  v_mfma_f32_16x16x32_bf16 v[152:155], v[8:11], v[40:43], v[152:155]
  v_accvgpr_write_b32 a159, 0
  v_accvgpr_write_b32 a169, 0
  v_mfma_f32_16x16x32_bf16 v[156:159], v[8:11], v[44:47], v[156:159]
  v_accvgpr_write_b32 a158, 0
  v_accvgpr_write_b32 a168, 0
  v_mfma_f32_16x16x32_bf16 v[160:163], v[8:11], v[48:51], v[160:163]
  v_accvgpr_write_b32 a157, 0
  v_accvgpr_write_b32 a167, 0
  v_mfma_f32_16x16x32_bf16 v[164:167], v[8:11], v[52:55], v[164:167]
  v_accvgpr_write_b32 a156, 0
  v_accvgpr_write_b32 a166, 0
  v_mfma_f32_16x16x32_bf16 v[168:171], v[12:15], v[32:35], v[168:171]
  v_accvgpr_write_b32 a155, 0
  v_accvgpr_write_b32 a165, 0
  v_mfma_f32_16x16x32_bf16 v[172:175], v[12:15], v[36:39], v[172:175]
  v_accvgpr_write_b32 a154, 0
  v_accvgpr_write_b32 a164, 0
  v_mfma_f32_16x16x32_bf16 v[176:179], v[12:15], v[40:43], v[176:179]
  v_accvgpr_write_b32 a153, 0
  v_accvgpr_write_b32 a163, 0
  v_mfma_f32_16x16x32_bf16 v[180:183], v[12:15], v[44:47], v[180:183]
  v_accvgpr_write_b32 a152, 0
  v_accvgpr_write_b32 a162, 0
  v_mfma_f32_16x16x32_bf16 v[184:187], v[12:15], v[48:51], v[184:187]
  v_accvgpr_write_b32 a151, 0
  v_accvgpr_write_b32 a161, 0
  v_mfma_f32_16x16x32_bf16 v[188:191], v[12:15], v[52:55], v[188:191]
  v_accvgpr_write_b32 a150, 0
  v_accvgpr_write_b32 a160, 0
  s_waitcnt lgkmcnt(0)
  s_waitcnt vmcnt(14)
  s_barrier
  v_mfma_f32_16x16x32_bf16 v[96:99], v[16:19], v[56:59], v[96:99]
  ds_read_b64_tr_b16 v[0:1], v232 offset:40960
  s_add_u32 m0, s43, 0
  s_add_u32 s44, s43, 16384
  buffer_load_dwordx4 v220, s[8:11], s44 offen offset:0 nt lds
  v_mfma_f32_16x16x32_bf16 v[100:103], v[16:19], v[60:63], v[100:103]
  ds_read_b64_tr_b16 v[2:3], v232 offset:41984
  v_mfma_f32_16x16x32_bf16 v[104:107], v[16:19], v[64:67], v[104:107]
  ds_read_b128 v[32:35], v228 offset:40960
  v_mfma_f32_16x16x32_bf16 v[108:111], v[16:19], v[68:71], v[108:111]
  ds_read_b128 v[36:39], v228 offset:43008
  buffer_load_dwordx4 v221, s[8:11], s44 offen offset:1024 nt lds
  v_mfma_f32_16x16x32_bf16 v[112:115], v[16:19], v[72:75], v[112:115]
  ds_read_b128 v[40:43], v228 offset:45056
  v_mfma_f32_16x16x32_bf16 v[116:119], v[16:19], v[76:79], v[116:119]
  ds_read_b128 v[44:47], v228 offset:47104
  v_mfma_f32_16x16x32_bf16 v[120:123], v[20:23], v[56:59], v[120:123]
  ds_read_b128 v[48:51], v228 offset:49152
  buffer_load_dwordx4 v222, s[8:11], s44 offen offset:2048 nt lds
  v_mfma_f32_16x16x32_bf16 v[124:127], v[20:23], v[60:63], v[124:127]
  ds_read_b128 v[52:55], v228 offset:51200
  v_mfma_f32_16x16x32_bf16 v[128:131], v[20:23], v[64:67], v[128:131]
  ds_read_b64_tr_b16 v[4:5], v232 offset:40968
  v_mfma_f32_16x16x32_bf16 v[132:135], v[20:23], v[68:71], v[132:135]
  ds_read_b64_tr_b16 v[6:7], v232 offset:41992
  buffer_load_dwordx4 v223, s[8:11], s44 offen offset:3072 nt lds
  v_mfma_f32_16x16x32_bf16 v[136:139], v[20:23], v[72:75], v[136:139]
  ds_read_b64_tr_b16 v[8:9], v233 offset:40960
  v_mfma_f32_16x16x32_bf16 v[140:143], v[20:23], v[76:79], v[140:143]
  ds_read_b64_tr_b16 v[10:11], v233 offset:41984
  v_mfma_f32_16x16x32_bf16 v[144:147], v[24:27], v[56:59], v[144:147]
  ds_read_b64_tr_b16 v[12:13], v233 offset:40968
  s_add_u32 m0, s43, 16384
  s_add_u32 s44, s43, 0
  buffer_load_dwordx4 v224, s[12:15], s44 offen offset:0 nt lds
  v_mfma_f32_16x16x32_bf16 v[148:151], v[24:27], v[60:63], v[148:151]
  ds_read_b64_tr_b16 v[14:15], v233 offset:41992
  v_mfma_f32_16x16x32_bf16 v[152:155], v[24:27], v[64:67], v[152:155]
  v_mfma_f32_16x16x32_bf16 v[156:159], v[24:27], v[68:71], v[156:159]
  buffer_load_dwordx4 v225, s[12:15], s44 offen offset:1024 nt lds
  v_mfma_f32_16x16x32_bf16 v[160:163], v[24:27], v[72:75], v[160:163]
  v_mfma_f32_16x16x32_bf16 v[164:167], v[24:27], v[76:79], v[164:167]
  v_mfma_f32_16x16x32_bf16 v[168:171], v[28:31], v[56:59], v[168:171]
  buffer_load_dwordx4 v224, s[12:15], s44 offen offset:2048 nt lds
  v_mfma_f32_16x16x32_bf16 v[172:175], v[28:31], v[60:63], v[172:175]
  v_mfma_f32_16x16x32_bf16 v[176:179], v[28:31], v[64:67], v[176:179]
  v_mfma_f32_16x16x32_bf16 v[180:183], v[28:31], v[68:71], v[180:183]
  buffer_load_dwordx4 v225, s[12:15], s44 offen offset:3072 nt lds
  v_mfma_f32_16x16x32_bf16 v[184:187], v[28:31], v[72:75], v[184:187]
  v_mfma_f32_16x16x32_bf16 v[188:191], v[28:31], v[76:79], v[188:191]
  s_waitcnt lgkmcnt(0)
  v_mfma_f32_16x16x32_bf16 v[96:99], v[0:3], v[32:35], v[96:99]
  ds_read_b64_tr_b16 v[16:17], v232 offset:49152
  v_mfma_f32_16x16x32_bf16 v[100:103], v[0:3], v[36:39], v[100:103]
  ds_read_b64_tr_b16 v[18:19], v232 offset:50176
  v_mfma_f32_16x16x32_bf16 v[104:107], v[0:3], v[40:43], v[104:107]
  ds_read_b128 v[56:59], v229 offset:40960
  v_mfma_f32_16x16x32_bf16 v[108:111], v[0:3], v[44:47], v[108:111]
  ds_read_b128 v[60:63], v229 offset:43008
  v_mfma_f32_16x16x32_bf16 v[112:115], v[0:3], v[48:51], v[112:115]
  ds_read_b128 v[64:67], v229 offset:45056
  v_mfma_f32_16x16x32_bf16 v[116:119], v[0:3], v[52:55], v[116:119]
  ds_read_b128 v[68:71], v229 offset:47104
  v_mfma_f32_16x16x32_bf16 v[120:123], v[4:7], v[32:35], v[120:123]
  ds_read_b128 v[72:75], v229 offset:49152
  v_mfma_f32_16x16x32_bf16 v[124:127], v[4:7], v[36:39], v[124:127]
  ds_read_b128 v[76:79], v229 offset:51200
  v_mfma_f32_16x16x32_bf16 v[128:131], v[4:7], v[40:43], v[128:131]
  ds_read_b64_tr_b16 v[20:21], v232 offset:49160
  v_mfma_f32_16x16x32_bf16 v[132:135], v[4:7], v[44:47], v[132:135]
  ds_read_b64_tr_b16 v[22:23], v232 offset:50184
  v_accvgpr_write_b32 a247, 0
  v_mfma_f32_16x16x32_bf16 v[136:139], v[4:7], v[48:51], v[136:139]
  ds_read_b64_tr_b16 v[24:25], v233 offset:49152
  v_accvgpr_write_b32 a246, 0
  v_mfma_f32_16x16x32_bf16 v[140:143], v[4:7], v[52:55], v[140:143]
  ds_read_b64_tr_b16 v[26:27], v233 offset:50176
  v_accvgpr_write_b32 a245, 0
  v_mfma_f32_16x16x32_bf16 v[144:147], v[8:11], v[32:35], v[144:147]
  ds_read_b64_tr_b16 v[28:29], v233 offset:49160
  v_accvgpr_write_b32 a244, 0
  v_mfma_f32_16x16x32_bf16 v[148:151], v[8:11], v[36:39], v[148:151]
  ds_read_b64_tr_b16 v[30:31], v233 offset:50184
  v_accvgpr_write_b32 a243, 0
  v_mfma_f32_16x16x32_bf16 v[152:155], v[8:11], v[40:43], v[152:155]
  v_accvgpr_write_b32 a184, 0
  v_accvgpr_write_b32 a242, 0
  v_mfma_f32_16x16x32_bf16 v[156:159], v[8:11], v[44:47], v[156:159]
  v_accvgpr_write_b32 a183, 0
  v_accvgpr_write_b32 a241, 0
  v_mfma_f32_16x16x32_bf16 v[160:163], v[8:11], v[48:51], v[160:163]
  v_accvgpr_write_b32 a182, 0
  v_accvgpr_write_b32 a240, 0
  v_mfma_f32_16x16x32_bf16 v[164:167], v[8:11], v[52:55], v[164:167]
  v_accvgpr_write_b32 a181, 0
  v_accvgpr_write_b32 a191, 0
  v_mfma_f32_16x16x32_bf16 v[168:171], v[12:15], v[32:35], v[168:171]
  v_accvgpr_write_b32 a180, 0
  v_accvgpr_write_b32 a190, 0
  v_mfma_f32_16x16x32_bf16 v[172:175], v[12:15], v[36:39], v[172:175]
  v_accvgpr_write_b32 a179, 0
  v_accvgpr_write_b32 a189, 0
  v_mfma_f32_16x16x32_bf16 v[176:179], v[12:15], v[40:43], v[176:179]
  v_accvgpr_write_b32 a178, 0
  v_accvgpr_write_b32 a188, 0
  v_mfma_f32_16x16x32_bf16 v[180:183], v[12:15], v[44:47], v[180:183]
  v_accvgpr_write_b32 a177, 0
  v_accvgpr_write_b32 a187, 0
  v_mfma_f32_16x16x32_bf16 v[184:187], v[12:15], v[48:51], v[184:187]
  v_accvgpr_write_b32 a176, 0
  v_accvgpr_write_b32 a186, 0
  v_mfma_f32_16x16x32_bf16 v[188:191], v[12:15], v[52:55], v[188:191]
  v_accvgpr_write_b32 a175, 0
  v_accvgpr_write_b32 a185, 0
  s_waitcnt lgkmcnt(0)
  s_waitcnt vmcnt(12)
  s_barrier
  v_mfma_f32_16x16x32_bf16 v[96:99], v[16:19], v[56:59], v[96:99]
  ds_read_b64_tr_b16 v[0:1], v234 offset:0
  v_mfma_f32_16x16x32_bf16 v[100:103], v[16:19], v[60:63], v[100:103]
  ds_read_b64_tr_b16 v[2:3], v234 offset:1024
  v_mfma_f32_16x16x32_bf16 v[104:107], v[16:19], v[64:67], v[104:107]
  ds_read_b128 v[32:35], v230 offset:0
  v_mfma_f32_16x16x32_bf16 v[108:111], v[16:19], v[68:71], v[108:111]
  ds_read_b128 v[36:39], v230 offset:2048
  v_mfma_f32_16x16x32_bf16 v[112:115], v[16:19], v[72:75], v[112:115]
  ds_read_b128 v[40:43], v230 offset:4096
  v_mfma_f32_16x16x32_bf16 v[116:119], v[16:19], v[76:79], v[116:119]
  ds_read_b128 v[44:47], v230 offset:6144
  v_mfma_f32_16x16x32_bf16 v[120:123], v[20:23], v[56:59], v[120:123]
  ds_read_b128 v[48:51], v230 offset:8192
  v_mfma_f32_16x16x32_bf16 v[124:127], v[20:23], v[60:63], v[124:127]
  ds_read_b128 v[52:55], v230 offset:10240
  v_mfma_f32_16x16x32_bf16 v[128:131], v[20:23], v[64:67], v[128:131]
  ds_read_b64_tr_b16 v[4:5], v234 offset:8
  v_mfma_f32_16x16x32_bf16 v[132:135], v[20:23], v[68:71], v[132:135]
  ds_read_b64_tr_b16 v[6:7], v234 offset:1032
  v_mfma_f32_16x16x32_bf16 v[136:139], v[20:23], v[72:75], v[136:139]
  ds_read_b64_tr_b16 v[8:9], v235 offset:0
  v_mfma_f32_16x16x32_bf16 v[140:143], v[20:23], v[76:79], v[140:143]
  ds_read_b64_tr_b16 v[10:11], v235 offset:1024
  v_mfma_f32_16x16x32_bf16 v[144:147], v[24:27], v[56:59], v[144:147]
  ds_read_b64_tr_b16 v[12:13], v235 offset:8
  v_mfma_f32_16x16x32_bf16 v[148:151], v[24:27], v[60:63], v[148:151]
  ds_read_b64_tr_b16 v[14:15], v235 offset:1032
  v_mfma_f32_16x16x32_bf16 v[152:155], v[24:27], v[64:67], v[152:155]
  v_mfma_f32_16x16x32_bf16 v[156:159], v[24:27], v[68:71], v[156:159]
  v_mfma_f32_16x16x32_bf16 v[160:163], v[24:27], v[72:75], v[160:163]
  v_mfma_f32_16x16x32_bf16 v[164:167], v[24:27], v[76:79], v[164:167]
  v_mfma_f32_16x16x32_bf16 v[168:171], v[28:31], v[56:59], v[168:171]
  v_mfma_f32_16x16x32_bf16 v[172:175], v[28:31], v[60:63], v[172:175]
  v_mfma_f32_16x16x32_bf16 v[176:179], v[28:31], v[64:67], v[176:179]
  v_mfma_f32_16x16x32_bf16 v[180:183], v[28:31], v[68:71], v[180:183]
  v_mfma_f32_16x16x32_bf16 v[184:187], v[28:31], v[72:75], v[184:187]
  v_mfma_f32_16x16x32_bf16 v[188:191], v[28:31], v[76:79], v[188:191]
  s_waitcnt lgkmcnt(0)
  v_mfma_f32_16x16x32_bf16 v[96:99], v[0:3], v[32:35], v[96:99]
  ds_read_b64_tr_b16 v[16:17], v234 offset:8192
  v_mfma_f32_16x16x32_bf16 v[100:103], v[0:3], v[36:39], v[100:103]
  ds_read_b64_tr_b16 v[18:19], v234 offset:9216
  v_mfma_f32_16x16x32_bf16 v[104:107], v[0:3], v[40:43], v[104:107]
  ds_read_b128 v[56:59], v231 offset:0
  v_mfma_f32_16x16x32_bf16 v[108:111], v[0:3], v[44:47], v[108:111]
  ds_read_b128 v[60:63], v231 offset:2048
  v_mfma_f32_16x16x32_bf16 v[112:115], v[0:3], v[48:51], v[112:115]
  ds_read_b128 v[64:67], v231 offset:4096
  v_mfma_f32_16x16x32_bf16 v[116:119], v[0:3], v[52:55], v[116:119]
  ds_read_b128 v[68:71], v231 offset:6144
  v_mfma_f32_16x16x32_bf16 v[120:123], v[4:7], v[32:35], v[120:123]
  ds_read_b128 v[72:75], v231 offset:8192
  v_mfma_f32_16x16x32_bf16 v[124:127], v[4:7], v[36:39], v[124:127]
  ds_read_b128 v[76:79], v231 offset:10240
  v_mfma_f32_16x16x32_bf16 v[128:131], v[4:7], v[40:43], v[128:131]
  ds_read_b64_tr_b16 v[20:21], v234 offset:8200
  v_mfma_f32_16x16x32_bf16 v[132:135], v[4:7], v[44:47], v[132:135]
  ds_read_b64_tr_b16 v[22:23], v234 offset:9224
  v_mfma_f32_16x16x32_bf16 v[136:139], v[4:7], v[48:51], v[136:139]
  ds_read_b64_tr_b16 v[24:25], v235 offset:8192
  v_mfma_f32_16x16x32_bf16 v[140:143], v[4:7], v[52:55], v[140:143]
  ds_read_b64_tr_b16 v[26:27], v235 offset:9216
  v_mfma_f32_16x16x32_bf16 v[144:147], v[8:11], v[32:35], v[144:147]
  ds_read_b64_tr_b16 v[28:29], v235 offset:8200
  v_mfma_f32_16x16x32_bf16 v[148:151], v[8:11], v[36:39], v[148:151]
  ds_read_b64_tr_b16 v[30:31], v235 offset:9224
  v_mfma_f32_16x16x32_bf16 v[152:155], v[8:11], v[40:43], v[152:155]
  v_mfma_f32_16x16x32_bf16 v[156:159], v[8:11], v[44:47], v[156:159]
  v_mfma_f32_16x16x32_bf16 v[160:163], v[8:11], v[48:51], v[160:163]
  v_accvgpr_write_b32 a255, 0
  v_mfma_f32_16x16x32_bf16 v[164:167], v[8:11], v[52:55], v[164:167]
  v_accvgpr_write_b32 a254, 0
  v_mfma_f32_16x16x32_bf16 v[168:171], v[12:15], v[32:35], v[168:171]
  v_accvgpr_write_b32 a253, 0
  v_mfma_f32_16x16x32_bf16 v[172:175], v[12:15], v[36:39], v[172:175]
  v_accvgpr_write_b32 a252, 0
  v_mfma_f32_16x16x32_bf16 v[176:179], v[12:15], v[40:43], v[176:179]
  v_accvgpr_write_b32 a251, 0
  v_mfma_f32_16x16x32_bf16 v[180:183], v[12:15], v[44:47], v[180:183]
  v_accvgpr_write_b32 a250, 0
  v_mfma_f32_16x16x32_bf16 v[184:187], v[12:15], v[48:51], v[184:187]
  v_accvgpr_write_b32 a249, 0
  v_mfma_f32_16x16x32_bf16 v[188:191], v[12:15], v[52:55], v[188:191]
  v_accvgpr_write_b32 a248, 0
  s_waitcnt lgkmcnt(0)
  s_waitcnt vmcnt(8)
  s_barrier
  v_mfma_f32_16x16x32_bf16 v[96:99], v[16:19], v[56:59], v[96:99]
  ds_read_b128 a[224:227], v254 offset:32768
  s_add_u32 m0, s43, 32768
  s_add_u32 s44, s43, 32768
  buffer_load_dwordx4 v220, s[8:11], s44 offen offset:0 nt lds
  v_mfma_f32_16x16x32_bf16 v[100:103], v[16:19], v[60:63], v[100:103]
  ds_read_b128 a[228:231], v254 offset:32832
  v_mfma_f32_16x16x32_bf16 v[104:107], v[16:19], v[64:67], v[104:107]
  ds_read_b128 a[232:235], v255 offset:32768
  v_mfma_f32_16x16x32_bf16 v[108:111], v[16:19], v[68:71], v[108:111]
  ds_read_b128 a[236:239], v255 offset:32832
  buffer_load_dwordx4 v221, s[8:11], s44 offen offset:1024 nt lds
  v_mfma_f32_16x16x32_bf16 v[112:115], v[16:19], v[72:75], v[112:115]
  ds_read_b128 a[192:195], v200 offset:32768
  v_mfma_f32_16x16x32_bf16 v[116:119], v[16:19], v[76:79], v[116:119]
  ds_read_b128 a[196:199], v200 offset:36864
  v_mfma_f32_16x16x32_bf16 v[120:123], v[20:23], v[56:59], v[120:123]
  ds_read_b128 a[200:203], v201 offset:32768
  buffer_load_dwordx4 v222, s[8:11], s44 offen offset:2048 nt lds
  v_mfma_f32_16x16x32_bf16 v[124:127], v[20:23], v[60:63], v[124:127]
  ds_read_b128 a[204:207], v201 offset:36864
  v_mfma_f32_16x16x32_bf16 v[128:131], v[20:23], v[64:67], v[128:131]
  ds_read_b128 a[208:211], v202 offset:32768
  v_mfma_f32_16x16x32_bf16 v[132:135], v[20:23], v[68:71], v[132:135]
  ds_read_b128 a[212:215], v202 offset:36864
  buffer_load_dwordx4 v223, s[8:11], s44 offen offset:3072 nt lds
  v_mfma_f32_16x16x32_bf16 v[136:139], v[20:23], v[72:75], v[136:139]
  ds_read_b128 a[216:219], v203 offset:32768
  v_mfma_f32_16x16x32_bf16 v[140:143], v[20:23], v[76:79], v[140:143]
  ds_read_b128 a[220:223], v203 offset:36864
  v_mfma_f32_16x16x32_bf16 v[144:147], v[24:27], v[56:59], v[144:147]
  s_add_u32 m0, s43, 49152
  s_add_u32 s44, s43, 16384
  buffer_load_dwordx4 v224, s[12:15], s44 offen offset:0 nt lds
  v_mfma_f32_16x16x32_bf16 v[148:151], v[24:27], v[60:63], v[148:151]
  v_mfma_f32_16x16x32_bf16 v[152:155], v[24:27], v[64:67], v[152:155]
  v_mfma_f32_16x16x32_bf16 v[156:159], v[24:27], v[68:71], v[156:159]
  buffer_load_dwordx4 v225, s[12:15], s44 offen offset:1024 nt lds
  v_mfma_f32_16x16x32_bf16 v[160:163], v[24:27], v[72:75], v[160:163]
  v_mfma_f32_16x16x32_bf16 v[164:167], v[24:27], v[76:79], v[164:167]
  v_mfma_f32_16x16x32_bf16 v[168:171], v[28:31], v[56:59], v[168:171]
  buffer_load_dwordx4 v224, s[12:15], s44 offen offset:2048 nt lds
  v_mfma_f32_16x16x32_bf16 v[172:175], v[28:31], v[60:63], v[172:175]
  v_mfma_f32_16x16x32_bf16 v[176:179], v[28:31], v[64:67], v[176:179]
  v_mfma_f32_16x16x32_bf16 v[180:183], v[28:31], v[68:71], v[180:183]
  buffer_load_dwordx4 v225, s[12:15], s44 offen offset:3072 nt lds
  v_mfma_f32_16x16x32_bf16 v[184:187], v[28:31], v[72:75], v[184:187]
  v_mfma_f32_16x16x32_bf16 v[188:191], v[28:31], v[76:79], v[188:191]
  s_nop 7
  s_waitcnt lgkmcnt(0)
  v_pk_mul_f32 v[96:97], v[96:97], s[48:49]
  v_pk_mul_f32 v[98:99], v[98:99], s[48:49]
  v_pk_mul_f32 v[120:121], v[120:121], s[48:49]
  v_pk_mul_f32 v[122:123], v[122:123], s[48:49]
  v_pk_mul_f32 v[144:145], v[144:145], s[48:49]
  v_pk_mul_f32 v[146:147], v[146:147], s[48:49]
  v_pk_mul_f32 v[168:169], v[168:169], s[48:49]
  v_pk_mul_f32 v[170:171], v[170:171], s[48:49]
  v_cvt_pk_bf16_f32 v0, v96, v97
  v_cvt_pk_bf16_f32 v1, v98, v99
  v_cvt_pk_bf16_f32 v2, v120, v121
  v_cvt_pk_bf16_f32 v3, v122, v123
  ds_write_b128 v252, v[0:3] offset:0
  v_cvt_pk_bf16_f32 v4, v144, v145
  v_cvt_pk_bf16_f32 v5, v146, v147
  v_cvt_pk_bf16_f32 v6, v168, v169
  v_cvt_pk_bf16_f32 v7, v170, v171
  ds_write_b128 v252, v[4:7] offset:1024
  v_mov_b32 v168, 0
  v_mov_b32 v169, 0
  v_mov_b32 v170, 0
  v_mov_b32 v171, 0
  v_pk_mul_f32 v[100:101], v[100:101], s[48:49]
  v_pk_mul_f32 v[102:103], v[102:103], s[48:49]
  v_pk_mul_f32 v[124:125], v[124:125], s[48:49]
  v_pk_mul_f32 v[126:127], v[126:127], s[48:49]
  v_pk_mul_f32 v[148:149], v[148:149], s[48:49]
  v_pk_mul_f32 v[150:151], v[150:151], s[48:49]
  v_pk_mul_f32 v[172:173], v[172:173], s[48:49]
  v_pk_mul_f32 v[174:175], v[174:175], s[48:49]
  v_mfma_f32_16x16x32_bf16 v[144:147], a[224:227], v[0:3], 0
  v_cvt_pk_bf16_f32 v16, v100, v101
  v_cvt_pk_bf16_f32 v17, v102, v103
  v_cvt_pk_bf16_f32 v18, v124, v125
  v_cvt_pk_bf16_f32 v19, v126, v127
  ds_write_b128 v252, v[16:19] offset:2048
  v_cvt_pk_bf16_f32 v20, v148, v149
  v_cvt_pk_bf16_f32 v21, v150, v151
  v_cvt_pk_bf16_f32 v22, v172, v173
  v_cvt_pk_bf16_f32 v23, v174, v175
  ds_write_b128 v252, v[20:23] offset:3072
  v_mfma_f32_16x16x32_bf16 v[144:147], a[228:231], v[4:7], v[144:147]
  v_mov_b32 v172, 0
  v_mov_b32 v173, 0
  v_mov_b32 v174, 0
  v_mov_b32 v175, 0
  v_pk_mul_f32 v[104:105], v[104:105], s[48:49]
  v_pk_mul_f32 v[106:107], v[106:107], s[48:49]
  v_pk_mul_f32 v[128:129], v[128:129], s[48:49]
  v_pk_mul_f32 v[130:131], v[130:131], s[48:49]
  v_pk_mul_f32 v[152:153], v[152:153], s[48:49]
  v_pk_mul_f32 v[154:155], v[154:155], s[48:49]
  v_pk_mul_f32 v[176:177], v[176:177], s[48:49]
  v_pk_mul_f32 v[178:179], v[178:179], s[48:49]
  v_mfma_f32_16x16x32_bf16 v[148:151], a[224:227], v[16:19], 0
  v_cvt_pk_bf16_f32 v32, v104, v105
  v_cvt_pk_bf16_f32 v33, v106, v107
  v_cvt_pk_bf16_f32 v34, v128, v129
  v_cvt_pk_bf16_f32 v35, v130, v131
  ds_write_b128 v252, v[32:35] offset:4096
  v_cvt_pk_bf16_f32 v36, v152, v153
  v_cvt_pk_bf16_f32 v37, v154, v155
  v_cvt_pk_bf16_f32 v38, v176, v177
  v_cvt_pk_bf16_f32 v39, v178, v179
  ds_write_b128 v252, v[36:39] offset:5120
  v_mfma_f32_16x16x32_bf16 v[148:151], a[228:231], v[20:23], v[148:151]
  v_mov_b32 v176, 0
  v_mov_b32 v177, 0
  v_mov_b32 v178, 0
  v_mov_b32 v179, 0
  v_pk_mul_f32 v[108:109], v[108:109], s[48:49]
  v_pk_mul_f32 v[110:111], v[110:111], s[48:49]
  v_pk_mul_f32 v[132:133], v[132:133], s[48:49]
  v_pk_mul_f32 v[134:135], v[134:135], s[48:49]
  v_pk_mul_f32 v[156:157], v[156:157], s[48:49]
  v_pk_mul_f32 v[158:159], v[158:159], s[48:49]
  v_pk_mul_f32 v[180:181], v[180:181], s[48:49]
  v_pk_mul_f32 v[182:183], v[182:183], s[48:49]
  v_mfma_f32_16x16x32_bf16 v[152:155], a[224:227], v[32:35], 0
  v_cvt_pk_bf16_f32 v48, v108, v109
  v_cvt_pk_bf16_f32 v49, v110, v111
  v_cvt_pk_bf16_f32 v50, v132, v133
  v_cvt_pk_bf16_f32 v51, v134, v135
  ds_write_b128 v252, v[48:51] offset:6144
  v_cvt_pk_bf16_f32 v52, v156, v157
  v_cvt_pk_bf16_f32 v53, v158, v159
  v_cvt_pk_bf16_f32 v54, v180, v181
  v_cvt_pk_bf16_f32 v55, v182, v183
  ds_write_b128 v252, v[52:55] offset:7168
  v_mfma_f32_16x16x32_bf16 v[152:155], a[228:231], v[36:39], v[152:155]
  v_mov_b32 v180, 0
  v_mov_b32 v181, 0
  v_mov_b32 v182, 0
  v_mov_b32 v183, 0
  v_pk_mul_f32 v[112:113], v[112:113], s[48:49]
  v_pk_mul_f32 v[114:115], v[114:115], s[48:49]
  v_pk_mul_f32 v[136:137], v[136:137], s[48:49]
  v_pk_mul_f32 v[138:139], v[138:139], s[48:49]
  v_pk_mul_f32 v[160:161], v[160:161], s[48:49]
  v_pk_mul_f32 v[162:163], v[162:163], s[48:49]
  v_pk_mul_f32 v[184:185], v[184:185], s[48:49]
  v_pk_mul_f32 v[186:187], v[186:187], s[48:49]
  v_mfma_f32_16x16x32_bf16 v[156:159], a[224:227], v[48:51], 0
  v_cvt_pk_bf16_f32 v64, v112, v113
  v_cvt_pk_bf16_f32 v65, v114, v115
  v_cvt_pk_bf16_f32 v66, v136, v137
  v_cvt_pk_bf16_f32 v67, v138, v139
  ds_write_b128 v252, v[64:67] offset:8192
  v_cvt_pk_bf16_f32 v68, v160, v161
  v_cvt_pk_bf16_f32 v69, v162, v163
  v_cvt_pk_bf16_f32 v70, v184, v185
  v_cvt_pk_bf16_f32 v71, v186, v187
  ds_write_b128 v252, v[68:71] offset:9216
  v_mfma_f32_16x16x32_bf16 v[156:159], a[228:231], v[52:55], v[156:159]
  v_mov_b32 v184, 0
  v_mov_b32 v185, 0
  v_mov_b32 v186, 0
  v_mov_b32 v187, 0
  v_pk_mul_f32 v[116:117], v[116:117], s[48:49]
  v_pk_mul_f32 v[118:119], v[118:119], s[48:49]
  v_pk_mul_f32 v[140:141], v[140:141], s[48:49]
  v_pk_mul_f32 v[142:143], v[142:143], s[48:49]
  v_pk_mul_f32 v[164:165], v[164:165], s[48:49]
  v_pk_mul_f32 v[166:167], v[166:167], s[48:49]
  v_pk_mul_f32 v[188:189], v[188:189], s[48:49]
  v_pk_mul_f32 v[190:191], v[190:191], s[48:49]
  v_mfma_f32_16x16x32_bf16 v[160:163], a[224:227], v[64:67], 0
  v_cvt_pk_bf16_f32 v80, v116, v117
  v_cvt_pk_bf16_f32 v81, v118, v119
  v_cvt_pk_bf16_f32 v82, v140, v141
  v_cvt_pk_bf16_f32 v83, v142, v143
  ds_write_b128 v252, v[80:83] offset:10240
  v_cvt_pk_bf16_f32 v84, v164, v165
  v_cvt_pk_bf16_f32 v85, v166, v167
  v_cvt_pk_bf16_f32 v86, v188, v189
  v_cvt_pk_bf16_f32 v87, v190, v191
  ds_write_b128 v252, v[84:87] offset:11264
  v_mfma_f32_16x16x32_bf16 v[160:163], a[228:231], v[68:71], v[160:163]
  v_mov_b32 v188, 0
  v_mov_b32 v189, 0
  v_mov_b32 v190, 0
  v_mov_b32 v191, 0
  v_mfma_f32_16x16x32_bf16 v[164:167], a[224:227], v[80:83], 0
  v_mov_b32 v136, 0
  v_mov_b32 v137, 0
  v_mov_b32 v138, 0
  v_mov_b32 v139, 0
  v_mov_b32 v140, 0
  v_mov_b32 v141, 0
  v_mov_b32 v142, 0
  v_mov_b32 v143, 0
  v_mfma_f32_16x16x32_bf16 v[164:167], a[228:231], v[84:87], v[164:167]
  s_waitcnt lgkmcnt(0)
  s_barrier
  ds_read_b128 v[8:11], v253 offset:0
  ds_read_b128 v[24:27], v253 offset:2048
  ds_read_b128 v[40:43], v253 offset:4096
  ds_read_b128 v[56:59], v253 offset:6144
  ds_read_b128 v[72:75], v253 offset:8192
  ds_read_b128 v[88:91], v253 offset:10240
  ds_read_b128 v[12:15], v253 offset:1024
  ds_read_b128 v[28:31], v253 offset:3072
  ds_read_b128 v[44:47], v253 offset:5120
  ds_read_b128 v[60:63], v253 offset:7168
  ds_read_b128 v[76:79], v253 offset:9216
  ds_read_b128 v[92:95], v253 offset:11264
  s_add_u32 m0, s43, 65536
  s_add_u32 s44, s43, 49152
  buffer_load_dwordx4 v220, s[8:11], s44 offen offset:0 nt lds
  buffer_load_dwordx4 v221, s[8:11], s44 offen offset:1024 nt lds
  buffer_load_dwordx4 v222, s[8:11], s44 offen offset:2048 nt lds
  buffer_load_dwordx4 v223, s[8:11], s44 offen offset:3072 nt lds
  s_waitcnt lgkmcnt(6)
  v_mfma_f32_16x16x32_bf16 v[144:147], a[232:235], v[8:11], v[144:147]
  s_add_u32 m0, s43, 81920
  s_add_u32 s44, s43, 32768
  buffer_load_dwordx4 v224, s[12:15], s44 offen offset:0 nt lds
  v_mfma_f32_16x16x32_bf16 v[148:151], a[232:235], v[24:27], v[148:151]
  buffer_load_dwordx4 v225, s[12:15], s44 offen offset:1024 nt lds
  v_mfma_f32_16x16x32_bf16 v[152:155], a[232:235], v[40:43], v[152:155]
  buffer_load_dwordx4 v224, s[12:15], s44 offen offset:2048 nt lds
  v_mfma_f32_16x16x32_bf16 v[156:159], a[232:235], v[56:59], v[156:159]
  buffer_load_dwordx4 v225, s[12:15], s44 offen offset:3072 nt lds
  v_mfma_f32_16x16x32_bf16 v[160:163], a[232:235], v[72:75], v[160:163]
  v_mfma_f32_16x16x32_bf16 v[164:167], a[232:235], v[88:91], v[164:167]
  s_waitcnt lgkmcnt(0)
  v_mfma_f32_16x16x32_bf16 v[144:147], a[236:239], v[12:15], v[144:147]
  v_mfma_f32_16x16x32_bf16 v[148:151], a[236:239], v[28:31], v[148:151]
  v_mfma_f32_16x16x32_bf16 v[152:155], a[236:239], v[44:47], v[152:155]
  v_mfma_f32_16x16x32_bf16 v[156:159], a[236:239], v[60:63], v[156:159]
  v_mfma_f32_16x16x32_bf16 v[160:163], a[236:239], v[76:79], v[160:163]
  v_mfma_f32_16x16x32_bf16 v[164:167], a[236:239], v[92:95], v[164:167]
  s_nop 7
  v_pk_mul_f32 v[144:145], v[144:145], s[98:99]
  v_pk_mul_f32 v[146:147], v[146:147], s[98:99]
  v_pk_mul_f32 v[148:149], v[148:149], s[98:99]
  v_pk_mul_f32 v[150:151], v[150:151], s[98:99]
  v_pk_mul_f32 v[152:153], v[152:153], s[98:99]
  v_pk_mul_f32 v[154:155], v[154:155], s[98:99]
  v_pk_mul_f32 v[156:157], v[156:157], s[98:99]
  v_pk_mul_f32 v[158:159], v[158:159], s[98:99]
  v_pk_mul_f32 v[160:161], v[160:161], s[98:99]
  v_pk_mul_f32 v[162:163], v[162:163], s[98:99]
  v_pk_mul_f32 v[164:165], v[164:165], s[98:99]
  v_pk_mul_f32 v[166:167], v[166:167], s[98:99]
  s_or_b32 s44, s3, s35
  s_or_b32 s44, s44, s41
  s_cmp_eq_u32 s44, 0
  s_cbranch_scc0 L_nordy
  s_lshl_b32 s44, s34, 4
  s_add_u32 s44, s44, 132
  v_mov_b32 v249, s44
  v_mov_b32 v247, 1
  s_mov_b64 exec, 1
  global_store_dword v249, v247, s[90:91] sc1
  s_mov_b64 exec, -1
L_nordy:
  s_cmp_eq_u32 s41, 0
  s_cbranch_scc0 L_maxpass
L_join:
  s_nop 1
  v_mfma_f32_16x16x32_bf16 v[96:99], a[192:195], v[0:3], v[144:147]
  v_accvgpr_write_b32 a224, 0
  v_mfma_f32_16x16x32_bf16 v[100:103], a[192:195], v[16:19], v[148:151]
  v_accvgpr_write_b32 a225, 0
  v_mfma_f32_16x16x32_bf16 v[104:107], a[196:199], v[0:3], v[144:147]
  v_accvgpr_write_b32 a226, 0
  v_mfma_f32_16x16x32_bf16 v[108:111], a[196:199], v[16:19], v[148:151]
  v_accvgpr_write_b32 a227, 0
  v_mfma_f32_16x16x32_bf16 v[96:99], a[200:203], v[4:7], v[96:99]
  v_accvgpr_write_b32 a228, 0
  v_mfma_f32_16x16x32_bf16 v[100:103], a[200:203], v[20:23], v[100:103]
  v_accvgpr_write_b32 a229, 0
  v_mfma_f32_16x16x32_bf16 v[104:107], a[204:207], v[4:7], v[104:107]
  v_accvgpr_write_b32 a230, 0
  v_mfma_f32_16x16x32_bf16 v[108:111], a[204:207], v[20:23], v[108:111]
  v_accvgpr_write_b32 a231, 0
  v_mfma_f32_16x16x32_bf16 v[96:99], a[208:211], v[8:11], v[96:99]
  v_accvgpr_write_b32 a232, 0
  v_mfma_f32_16x16x32_bf16 v[100:103], a[208:211], v[24:27], v[100:103]
  v_accvgpr_write_b32 a233, 0
  v_mfma_f32_16x16x32_bf16 v[104:107], a[212:215], v[8:11], v[104:107]
  v_accvgpr_write_b32 a234, 0
  v_mfma_f32_16x16x32_bf16 v[108:111], a[212:215], v[24:27], v[108:111]
  v_accvgpr_write_b32 a235, 0
  v_mfma_f32_16x16x32_bf16 v[96:99], a[216:219], v[12:15], v[96:99]
  v_accvgpr_write_b32 a236, 0
  v_mfma_f32_16x16x32_bf16 v[100:103], a[216:219], v[28:31], v[100:103]
  v_accvgpr_write_b32 a237, 0
  v_mfma_f32_16x16x32_bf16 v[104:107], a[220:223], v[12:15], v[104:107]
  v_accvgpr_write_b32 a238, 0
  v_mfma_f32_16x16x32_bf16 v[108:111], a[220:223], v[28:31], v[108:111]
  v_accvgpr_write_b32 a239, 0
  s_mov_b32 s40, 0
L_loop:
  s_sub_u32 s44, s92, 4
  s_cmp_eq_u32 s40, s44
  s_cbranch_scc0 L_nordp
  v_lshrrev_b32 v249, 0, v226
  s_mov_b64 exec, 0xff
  global_load_dword v246, v249, s[90:91] offset:132 sc1
  s_mov_b64 exec, -1
L_nordp:
  s_cmp_eq_u32 s40, s92
  s_cbranch_scc0 L_notk
  s_mov_b32 s45, 300000
  v_mov_b32 v249, v226
L_rdchk:
  s_mov_b64 exec, 0xff
  v_cmp_eq_u32 vcc, 0, v246
  s_cbranch_vccz L_rdok
  s_sleep 8
  global_load_dword v246, v249, s[90:91] offset:132 sc1
  s_waitcnt vmcnt(0)
  s_sub_u32 s45, s45, 1
  s_cmp_eq_u32 s45, 0
  s_cbranch_scc0 L_rdchk
L_rdok:
  s_and_b32 s44, s2, 7
  s_lshl_b32 s44, s44, 13
  s_add_u32 s44, s44, 7936
  s_mov_b64 exec, 1
  v_mov_b32 v249, s44
  v_mov_b32 v247, 1
  s_nop 0
  global_atomic_add v248, v249, v247, s[94:95] sc0
  s_and_b32 s44, s2, 7
  s_mul_i32 s44, s44, 221184
  v_mov_b32 v245, s44
  global_load_dword v244, v245, s[88:89]
  s_mul_i32 s44, s34, 1572864
  v_mov_b32 v245, s44
  global_load_dword v244, v245, s[32:33]
  s_and_b32 s44, s2, 7
  s_mul_i32 s44, s44, 1572864
  v_mov_b32 v245, s44
  global_load_dword v244, v245, s[32:33]
  s_mov_b64 exec, -1
L_notk:
  s_waitcnt vmcnt(16)
  s_barrier
  v_mfma_f32_16x16x32_bf16 v[112:115], a[192:195], v[32:35], v[152:155]
  s_add_u32 m0, s43, 98304
  s_nop 0
  buffer_load_dwordx4 v220, s[8:11], s38 offen offset:0 nt lds
  v_mfma_f32_16x16x32_bf16 v[116:119], a[192:195], v[48:51], v[156:159]
  buffer_load_dwordx4 v221, s[8:11], s38 offen offset:1024 nt lds
  v_mfma_f32_16x16x32_bf16 v[120:123], a[196:199], v[32:35], v[152:155]
  buffer_load_dwordx4 v222, s[8:11], s38 offen offset:2048 nt lds
  v_mfma_f32_16x16x32_bf16 v[124:127], a[196:199], v[48:51], v[156:159]
  buffer_load_dwordx4 v223, s[8:11], s38 offen offset:3072 nt lds
  v_mfma_f32_16x16x32_bf16 v[112:115], a[200:203], v[36:39], v[112:115]
  s_add_u32 s38, s38, 16384
  v_mfma_f32_16x16x32_bf16 v[116:119], a[200:203], v[52:55], v[116:119]
  v_exp_f32 v96, v96
  v_mfma_f32_16x16x32_bf16 v[120:123], a[204:207], v[36:39], v[120:123]
  v_exp_f32 v97, v97
  v_mfma_f32_16x16x32_bf16 v[124:127], a[204:207], v[52:55], v[124:127]
  v_exp_f32 v98, v98
  v_mfma_f32_16x16x32_bf16 v[112:115], a[208:211], v[40:43], v[112:115]
  v_exp_f32 v99, v99
  v_mfma_f32_16x16x32_bf16 v[116:119], a[208:211], v[56:59], v[116:119]
  v_exp_f32 v104, v104
  v_mfma_f32_16x16x32_bf16 v[120:123], a[212:215], v[40:43], v[120:123]
  v_exp_f32 v105, v105
  v_mfma_f32_16x16x32_bf16 v[124:127], a[212:215], v[56:59], v[124:127]
  v_exp_f32 v106, v106
  v_mfma_f32_16x16x32_bf16 v[112:115], a[216:219], v[44:47], v[112:115]
  v_exp_f32 v107, v107
  v_mfma_f32_16x16x32_bf16 v[116:119], a[216:219], v[60:63], v[116:119]
  v_exp_f32 v100, v100
  v_mfma_f32_16x16x32_bf16 v[120:123], a[220:223], v[44:47], v[120:123]
  v_exp_f32 v101, v101
  v_mfma_f32_16x16x32_bf16 v[124:127], a[220:223], v[60:63], v[124:127]
  v_exp_f32 v102, v102
  v_mfma_f32_16x16x32_bf16 a[128:131], a[224:227], v[136:139], a[128:131]
  v_exp_f32 v103, v103
  v_mfma_f32_16x16x32_bf16 a[160:163], a[224:227], v[140:143], a[160:163]
  ds_read_b64_tr_b16 a[224:225], v204 offset:0
  ds_read_b64_tr_b16 a[226:227], v204 offset:4096
  v_mfma_f32_16x16x32_bf16 a[132:135], a[228:231], v[136:139], a[132:135]
  v_exp_f32 v108, v108
  v_mfma_f32_16x16x32_bf16 a[164:167], a[228:231], v[140:143], a[164:167]
  ds_read_b64_tr_b16 a[228:229], v205 offset:0
  ds_read_b64_tr_b16 a[230:231], v205 offset:4096
  v_mfma_f32_16x16x32_bf16 a[136:139], a[232:235], v[136:139], a[136:139]
  v_exp_f32 v109, v109
  v_mfma_f32_16x16x32_bf16 a[168:171], a[232:235], v[140:143], a[168:171]
  ds_read_b64_tr_b16 a[232:233], v206 offset:0
  ds_read_b64_tr_b16 a[234:235], v206 offset:4096
  v_mfma_f32_16x16x32_bf16 a[140:143], a[236:239], v[136:139], a[140:143]
  v_exp_f32 v110, v110
  v_mfma_f32_16x16x32_bf16 a[172:175], a[236:239], v[140:143], a[172:175]
  ds_read_b64_tr_b16 a[236:237], v207 offset:0
  ds_read_b64_tr_b16 a[238:239], v207 offset:4096
  v_mfma_f32_16x16x32_bf16 a[144:147], a[240:243], v[136:139], a[144:147]
  v_exp_f32 v111, v111
  v_mfma_f32_16x16x32_bf16 a[176:179], a[240:243], v[140:143], a[176:179]
  ds_read_b64_tr_b16 a[240:241], v208 offset:0
  ds_read_b64_tr_b16 a[242:243], v208 offset:4096
  v_mfma_f32_16x16x32_bf16 a[148:151], a[244:247], v[136:139], a[148:151]
  v_cvt_pk_bf16_f32 v128, v96, v97
  v_cvt_pk_bf16_f32 v129, v98, v99
  v_mfma_f32_16x16x32_bf16 a[180:183], a[244:247], v[140:143], a[180:183]
  ds_read_b64_tr_b16 a[244:245], v209 offset:0
  ds_read_b64_tr_b16 a[246:247], v209 offset:4096
  v_mfma_f32_16x16x32_bf16 a[152:155], a[248:251], v[136:139], a[152:155]
  v_cvt_pk_bf16_f32 v130, v104, v105
  v_cvt_pk_bf16_f32 v131, v106, v107
  v_mfma_f32_16x16x32_bf16 a[184:187], a[248:251], v[140:143], a[184:187]
  ds_read_b64_tr_b16 a[248:249], v210 offset:0
  ds_read_b64_tr_b16 a[250:251], v210 offset:4096
  v_mfma_f32_16x16x32_bf16 a[156:159], a[252:255], v[136:139], a[156:159]
  v_cvt_pk_bf16_f32 v132, v100, v101
  v_cvt_pk_bf16_f32 v133, v102, v103
  v_mfma_f32_16x16x32_bf16 a[188:191], a[252:255], v[140:143], a[188:191]
  ds_read_b64_tr_b16 a[252:253], v211 offset:0
  ds_read_b64_tr_b16 a[254:255], v211 offset:4096
  v_mfma_f32_16x16x32_bf16 v[184:187], v[192:195], v[136:139], v[184:187]
  v_cvt_pk_bf16_f32 v134, v108, v109
  v_cvt_pk_bf16_f32 v135, v110, v111
  v_mfma_f32_16x16x32_bf16 v[188:191], v[192:195], v[140:143], v[188:191]
  v_mfma_f32_16x16x32_bf16 v[96:99], a[192:195], v[64:67], v[160:163]
  v_exp_f32 v112, v112
  v_mfma_f32_16x16x32_bf16 v[100:103], a[192:195], v[80:83], v[164:167]
  v_exp_f32 v113, v113
  v_mfma_f32_16x16x32_bf16 v[104:107], a[196:199], v[64:67], v[160:163]
  v_exp_f32 v114, v114
  v_mfma_f32_16x16x32_bf16 v[108:111], a[196:199], v[80:83], v[164:167]
  v_exp_f32 v115, v115
  v_mfma_f32_16x16x32_bf16 v[96:99], a[200:203], v[68:71], v[96:99]
  v_exp_f32 v120, v120
  v_mfma_f32_16x16x32_bf16 v[100:103], a[200:203], v[84:87], v[100:103]
  v_exp_f32 v121, v121
  v_mfma_f32_16x16x32_bf16 v[104:107], a[204:207], v[68:71], v[104:107]
  v_exp_f32 v122, v122
  v_mfma_f32_16x16x32_bf16 v[108:111], a[204:207], v[84:87], v[108:111]
  v_exp_f32 v123, v123
  v_mfma_f32_16x16x32_bf16 v[96:99], a[208:211], v[72:75], v[96:99]
  v_exp_f32 v116, v116
  v_mfma_f32_16x16x32_bf16 v[100:103], a[208:211], v[88:91], v[100:103]
  v_exp_f32 v117, v117
  v_mfma_f32_16x16x32_bf16 v[104:107], a[212:215], v[72:75], v[104:107]
  v_exp_f32 v118, v118
  v_mfma_f32_16x16x32_bf16 v[108:111], a[212:215], v[88:91], v[108:111]
  v_exp_f32 v119, v119
  v_mfma_f32_16x16x32_bf16 v[96:99], a[216:219], v[76:79], v[96:99]
  v_exp_f32 v124, v124
  v_mfma_f32_16x16x32_bf16 v[100:103], a[216:219], v[92:95], v[100:103]
  v_exp_f32 v125, v125
  v_mfma_f32_16x16x32_bf16 v[104:107], a[220:223], v[76:79], v[104:107]
  v_exp_f32 v126, v126
  v_mfma_f32_16x16x32_bf16 v[108:111], a[220:223], v[92:95], v[108:111]
  s_waitcnt lgkmcnt(0)
  v_cvt_pk_bf16_f32 v136, v112, v113
  v_mfma_f32_16x16x32_bf16 a[0:3], a[224:227], v[128:131], a[0:3]
  ds_read_b128 a[192:195], v196 offset:0
  v_cvt_pk_bf16_f32 v137, v114, v115
  v_mfma_f32_16x16x32_bf16 a[32:35], a[224:227], v[132:135], a[32:35]
  ds_read_b128 a[196:199], v196 offset:4096
  v_cvt_pk_bf16_f32 v138, v120, v121
  v_mfma_f32_16x16x32_bf16 a[4:7], a[228:231], v[128:131], a[4:7]
  ds_read_b128 a[200:203], v197 offset:0
  v_cvt_pk_bf16_f32 v139, v122, v123
  v_mfma_f32_16x16x32_bf16 a[36:39], a[228:231], v[132:135], a[36:39]
  ds_read_b128 a[204:207], v197 offset:4096
  v_cvt_pk_bf16_f32 v140, v116, v117
  v_mfma_f32_16x16x32_bf16 a[8:11], a[232:235], v[128:131], a[8:11]
  ds_read_b128 a[208:211], v198 offset:0
  v_cvt_pk_bf16_f32 v141, v118, v119
  v_mfma_f32_16x16x32_bf16 a[40:43], a[232:235], v[132:135], a[40:43]
  ds_read_b128 a[212:215], v198 offset:4096
  v_cvt_pk_bf16_f32 v142, v124, v125
  v_mfma_f32_16x16x32_bf16 a[12:15], a[236:239], v[128:131], a[12:15]
  ds_read_b128 a[216:219], v199 offset:0
  v_mfma_f32_16x16x32_bf16 a[44:47], a[236:239], v[132:135], a[44:47]
  ds_read_b128 a[220:223], v199 offset:4096
  v_mfma_f32_16x16x32_bf16 a[16:19], a[240:243], v[128:131], a[16:19]
  s_add_u32 m0, s43, 114688
  s_nop 0
  buffer_load_dwordx4 v224, s[12:15], s39 offen offset:0 nt lds
  v_mfma_f32_16x16x32_bf16 a[48:51], a[240:243], v[132:135], a[48:51]
  buffer_load_dwordx4 v225, s[12:15], s39 offen offset:1024 nt lds
  v_mfma_f32_16x16x32_bf16 a[20:23], a[244:247], v[128:131], a[20:23]
  buffer_load_dwordx4 v224, s[12:15], s39 offen offset:2048 nt lds
  v_mfma_f32_16x16x32_bf16 a[52:55], a[244:247], v[132:135], a[52:55]
  buffer_load_dwordx4 v225, s[12:15], s39 offen offset:3072 nt lds
  v_mfma_f32_16x16x32_bf16 a[24:27], a[248:251], v[128:131], a[24:27]
  s_add_u32 s39, s39, 16384
  v_mfma_f32_16x16x32_bf16 a[56:59], a[248:251], v[132:135], a[56:59]
  v_exp_f32 v127, v127
  v_mfma_f32_16x16x32_bf16 a[28:31], a[252:255], v[128:131], a[28:31]
  v_cvt_pk_bf16_f32 v143, v126, v127
  v_mfma_f32_16x16x32_bf16 a[60:63], a[252:255], v[132:135], a[60:63]
  v_mfma_f32_16x16x32_bf16 v[168:171], v[192:195], v[128:131], v[168:171]
  v_mfma_f32_16x16x32_bf16 v[172:175], v[192:195], v[132:135], v[172:175]
  s_waitcnt lgkmcnt(0)
  v_mfma_f32_16x16x32_bf16 v[112:115], a[192:195], v[0:3], v[144:147]
  v_exp_f32 v96, v96
  v_mfma_f32_16x16x32_bf16 v[116:119], a[192:195], v[16:19], v[148:151]
  v_exp_f32 v97, v97
  v_mfma_f32_16x16x32_bf16 v[120:123], a[196:199], v[0:3], v[144:147]
  v_exp_f32 v98, v98
  v_mfma_f32_16x16x32_bf16 v[124:127], a[196:199], v[16:19], v[148:151]
  v_exp_f32 v99, v99
  v_mfma_f32_16x16x32_bf16 v[112:115], a[200:203], v[4:7], v[112:115]
  v_exp_f32 v104, v104
  v_mfma_f32_16x16x32_bf16 v[116:119], a[200:203], v[20:23], v[116:119]
  v_exp_f32 v105, v105
  v_mfma_f32_16x16x32_bf16 v[120:123], a[204:207], v[4:7], v[120:123]
  v_exp_f32 v106, v106
  v_mfma_f32_16x16x32_bf16 v[124:127], a[204:207], v[20:23], v[124:127]
  v_exp_f32 v107, v107
  v_mfma_f32_16x16x32_bf16 v[112:115], a[208:211], v[8:11], v[112:115]
  v_exp_f32 v100, v100
  v_mfma_f32_16x16x32_bf16 v[116:119], a[208:211], v[24:27], v[116:119]
  v_exp_f32 v101, v101
  v_mfma_f32_16x16x32_bf16 v[120:123], a[212:215], v[8:11], v[120:123]
  v_exp_f32 v102, v102
  v_mfma_f32_16x16x32_bf16 v[124:127], a[212:215], v[24:27], v[124:127]
  v_exp_f32 v103, v103
  v_mfma_f32_16x16x32_bf16 v[112:115], a[216:219], v[12:15], v[112:115]
  v_exp_f32 v108, v108
  v_mfma_f32_16x16x32_bf16 v[116:119], a[216:219], v[28:31], v[116:119]
  v_exp_f32 v109, v109
  v_mfma_f32_16x16x32_bf16 v[120:123], a[220:223], v[12:15], v[120:123]
  v_exp_f32 v110, v110
  v_mfma_f32_16x16x32_bf16 v[124:127], a[220:223], v[28:31], v[124:127]
  v_exp_f32 v111, v111
  v_mfma_f32_16x16x32_bf16 a[64:67], a[224:227], v[136:139], a[64:67]
  v_cvt_pk_bf16_f32 v128, v96, v97
  v_cvt_pk_bf16_f32 v129, v98, v99
  v_mfma_f32_16x16x32_bf16 a[96:99], a[224:227], v[140:143], a[96:99]
  v_cvt_pk_bf16_f32 v130, v104, v105
  v_cvt_pk_bf16_f32 v131, v106, v107
  v_mfma_f32_16x16x32_bf16 a[68:71], a[228:231], v[136:139], a[68:71]
  v_cvt_pk_bf16_f32 v132, v100, v101
  v_cvt_pk_bf16_f32 v133, v102, v103
  v_mfma_f32_16x16x32_bf16 a[100:103], a[228:231], v[140:143], a[100:103]
  v_cvt_pk_bf16_f32 v134, v108, v109
  v_cvt_pk_bf16_f32 v135, v110, v111
  v_mfma_f32_16x16x32_bf16 a[72:75], a[232:235], v[136:139], a[72:75]
  v_mfma_f32_16x16x32_bf16 a[104:107], a[232:235], v[140:143], a[104:107]
  v_mfma_f32_16x16x32_bf16 a[76:79], a[236:239], v[136:139], a[76:79]
  v_mfma_f32_16x16x32_bf16 a[108:111], a[236:239], v[140:143], a[108:111]
  v_mfma_f32_16x16x32_bf16 a[80:83], a[240:243], v[136:139], a[80:83]
  v_mfma_f32_16x16x32_bf16 a[112:115], a[240:243], v[140:143], a[112:115]
  v_mfma_f32_16x16x32_bf16 a[84:87], a[244:247], v[136:139], a[84:87]
  v_mfma_f32_16x16x32_bf16 a[116:119], a[244:247], v[140:143], a[116:119]
  v_mfma_f32_16x16x32_bf16 a[88:91], a[248:251], v[136:139], a[88:91]
  v_mfma_f32_16x16x32_bf16 a[120:123], a[248:251], v[140:143], a[120:123]
  v_mfma_f32_16x16x32_bf16 a[92:95], a[252:255], v[136:139], a[92:95]
  v_mfma_f32_16x16x32_bf16 a[124:127], a[252:255], v[140:143], a[124:127]
  v_mfma_f32_16x16x32_bf16 v[176:179], v[192:195], v[136:139], v[176:179]
  v_mfma_f32_16x16x32_bf16 v[180:183], v[192:195], v[140:143], v[180:183]
  s_waitcnt vmcnt(16)
  s_barrier
  v_mfma_f32_16x16x32_bf16 v[96:99], a[192:195], v[32:35], v[152:155]
  s_add_u32 m0, s43, 0
  s_nop 0
  buffer_load_dwordx4 v220, s[8:11], s38 offen offset:0 nt lds
  v_mfma_f32_16x16x32_bf16 v[100:103], a[192:195], v[48:51], v[156:159]
  buffer_load_dwordx4 v221, s[8:11], s38 offen offset:1024 nt lds
  v_mfma_f32_16x16x32_bf16 v[104:107], a[196:199], v[32:35], v[152:155]
  buffer_load_dwordx4 v222, s[8:11], s38 offen offset:2048 nt lds
  v_mfma_f32_16x16x32_bf16 v[108:111], a[196:199], v[48:51], v[156:159]
  buffer_load_dwordx4 v223, s[8:11], s38 offen offset:3072 nt lds
  v_mfma_f32_16x16x32_bf16 v[96:99], a[200:203], v[36:39], v[96:99]
  s_add_u32 s38, s38, 16384
  v_mfma_f32_16x16x32_bf16 v[100:103], a[200:203], v[52:55], v[100:103]
  v_exp_f32 v112, v112
  v_mfma_f32_16x16x32_bf16 v[104:107], a[204:207], v[36:39], v[104:107]
  v_exp_f32 v113, v113
  v_mfma_f32_16x16x32_bf16 v[108:111], a[204:207], v[52:55], v[108:111]
  v_exp_f32 v114, v114
  v_mfma_f32_16x16x32_bf16 v[96:99], a[208:211], v[40:43], v[96:99]
  v_exp_f32 v115, v115
  v_mfma_f32_16x16x32_bf16 v[100:103], a[208:211], v[56:59], v[100:103]
  v_exp_f32 v120, v120
  v_mfma_f32_16x16x32_bf16 v[104:107], a[212:215], v[40:43], v[104:107]
  v_exp_f32 v121, v121
  v_mfma_f32_16x16x32_bf16 v[108:111], a[212:215], v[56:59], v[108:111]
  v_exp_f32 v122, v122
  v_mfma_f32_16x16x32_bf16 v[96:99], a[216:219], v[44:47], v[96:99]
  v_exp_f32 v123, v123
  v_mfma_f32_16x16x32_bf16 v[100:103], a[216:219], v[60:63], v[100:103]
  v_exp_f32 v116, v116
  v_mfma_f32_16x16x32_bf16 v[104:107], a[220:223], v[44:47], v[104:107]
  v_exp_f32 v117, v117
  v_mfma_f32_16x16x32_bf16 v[108:111], a[220:223], v[60:63], v[108:111]
  v_exp_f32 v118, v118
  v_mfma_f32_16x16x32_bf16 a[128:131], a[224:227], v[128:131], a[128:131]
  v_exp_f32 v119, v119
  v_mfma_f32_16x16x32_bf16 a[160:163], a[224:227], v[132:135], a[160:163]
  ds_read_b64_tr_b16 a[224:225], v204 offset:32768
  ds_read_b64_tr_b16 a[226:227], v204 offset:36864
  v_mfma_f32_16x16x32_bf16 a[132:135], a[228:231], v[128:131], a[132:135]
  v_exp_f32 v124, v124
  v_mfma_f32_16x16x32_bf16 a[164:167], a[228:231], v[132:135], a[164:167]
  ds_read_b64_tr_b16 a[228:229], v205 offset:32768
  ds_read_b64_tr_b16 a[230:231], v205 offset:36864
  v_mfma_f32_16x16x32_bf16 a[136:139], a[232:235], v[128:131], a[136:139]
  v_exp_f32 v125, v125
  v_mfma_f32_16x16x32_bf16 a[168:171], a[232:235], v[132:135], a[168:171]
  ds_read_b64_tr_b16 a[232:233], v206 offset:32768
  ds_read_b64_tr_b16 a[234:235], v206 offset:36864
  v_mfma_f32_16x16x32_bf16 a[140:143], a[236:239], v[128:131], a[140:143]
  v_exp_f32 v126, v126
  v_mfma_f32_16x16x32_bf16 a[172:175], a[236:239], v[132:135], a[172:175]
  ds_read_b64_tr_b16 a[236:237], v207 offset:32768
  ds_read_b64_tr_b16 a[238:239], v207 offset:36864
  v_mfma_f32_16x16x32_bf16 a[144:147], a[240:243], v[128:131], a[144:147]
  v_exp_f32 v127, v127
  v_mfma_f32_16x16x32_bf16 a[176:179], a[240:243], v[132:135], a[176:179]
  ds_read_b64_tr_b16 a[240:241], v208 offset:32768
  ds_read_b64_tr_b16 a[242:243], v208 offset:36864
  v_mfma_f32_16x16x32_bf16 a[148:151], a[244:247], v[128:131], a[148:151]
  v_cvt_pk_bf16_f32 v136, v112, v113
  v_cvt_pk_bf16_f32 v137, v114, v115
  v_mfma_f32_16x16x32_bf16 a[180:183], a[244:247], v[132:135], a[180:183]
  ds_read_b64_tr_b16 a[244:245], v209 offset:32768
  ds_read_b64_tr_b16 a[246:247], v209 offset:36864
  v_mfma_f32_16x16x32_bf16 a[152:155], a[248:251], v[128:131], a[152:155]
  v_cvt_pk_bf16_f32 v138, v120, v121
  v_cvt_pk_bf16_f32 v139, v122, v123
  v_mfma_f32_16x16x32_bf16 a[184:187], a[248:251], v[132:135], a[184:187]
  ds_read_b64_tr_b16 a[248:249], v210 offset:32768
  ds_read_b64_tr_b16 a[250:251], v210 offset:36864
  v_mfma_f32_16x16x32_bf16 a[156:159], a[252:255], v[128:131], a[156:159]
  v_cvt_pk_bf16_f32 v140, v116, v117
  v_cvt_pk_bf16_f32 v141, v118, v119
  v_mfma_f32_16x16x32_bf16 a[188:191], a[252:255], v[132:135], a[188:191]
  ds_read_b64_tr_b16 a[252:253], v211 offset:32768
  ds_read_b64_tr_b16 a[254:255], v211 offset:36864
  v_mfma_f32_16x16x32_bf16 v[184:187], v[192:195], v[128:131], v[184:187]
  v_cvt_pk_bf16_f32 v142, v124, v125
  v_cvt_pk_bf16_f32 v143, v126, v127
  v_mfma_f32_16x16x32_bf16 v[188:191], v[192:195], v[132:135], v[188:191]
  v_mfma_f32_16x16x32_bf16 v[112:115], a[192:195], v[64:67], v[160:163]
  v_exp_f32 v96, v96
  v_mfma_f32_16x16x32_bf16 v[116:119], a[192:195], v[80:83], v[164:167]
  v_exp_f32 v97, v97
  v_mfma_f32_16x16x32_bf16 v[120:123], a[196:199], v[64:67], v[160:163]
  v_exp_f32 v98, v98
  v_mfma_f32_16x16x32_bf16 v[124:127], a[196:199], v[80:83], v[164:167]
  v_exp_f32 v99, v99
  v_mfma_f32_16x16x32_bf16 v[112:115], a[200:203], v[68:71], v[112:115]
  v_exp_f32 v104, v104
  v_mfma_f32_16x16x32_bf16 v[116:119], a[200:203], v[84:87], v[116:119]
  v_exp_f32 v105, v105
  v_mfma_f32_16x16x32_bf16 v[120:123], a[204:207], v[68:71], v[120:123]
  v_exp_f32 v106, v106
  v_mfma_f32_16x16x32_bf16 v[124:127], a[204:207], v[84:87], v[124:127]
  v_exp_f32 v107, v107
  v_mfma_f32_16x16x32_bf16 v[112:115], a[208:211], v[72:75], v[112:115]
  v_exp_f32 v100, v100
  v_mfma_f32_16x16x32_bf16 v[116:119], a[208:211], v[88:91], v[116:119]
  v_exp_f32 v101, v101
  v_mfma_f32_16x16x32_bf16 v[120:123], a[212:215], v[72:75], v[120:123]
  v_exp_f32 v102, v102
  v_mfma_f32_16x16x32_bf16 v[124:127], a[212:215], v[88:91], v[124:127]
  v_exp_f32 v103, v103
  v_mfma_f32_16x16x32_bf16 v[112:115], a[216:219], v[76:79], v[112:115]
  v_exp_f32 v108, v108
  v_mfma_f32_16x16x32_bf16 v[116:119], a[216:219], v[92:95], v[116:119]
  v_exp_f32 v109, v109
  v_mfma_f32_16x16x32_bf16 v[120:123], a[220:223], v[76:79], v[120:123]
  v_exp_f32 v110, v110
  v_mfma_f32_16x16x32_bf16 v[124:127], a[220:223], v[92:95], v[124:127]
  s_waitcnt lgkmcnt(0)
  v_cvt_pk_bf16_f32 v128, v96, v97
  v_mfma_f32_16x16x32_bf16 a[0:3], a[224:227], v[136:139], a[0:3]
  ds_read_b128 a[192:195], v196 offset:32768
  v_cvt_pk_bf16_f32 v129, v98, v99
  v_mfma_f32_16x16x32_bf16 a[32:35], a[224:227], v[140:143], a[32:35]
  ds_read_b128 a[196:199], v196 offset:36864
  v_cvt_pk_bf16_f32 v130, v104, v105
  v_mfma_f32_16x16x32_bf16 a[4:7], a[228:231], v[136:139], a[4:7]
  ds_read_b128 a[200:203], v197 offset:32768
  v_cvt_pk_bf16_f32 v131, v106, v107
  v_mfma_f32_16x16x32_bf16 a[36:39], a[228:231], v[140:143], a[36:39]
  ds_read_b128 a[204:207], v197 offset:36864
  v_cvt_pk_bf16_f32 v132, v100, v101
  v_mfma_f32_16x16x32_bf16 a[8:11], a[232:235], v[136:139], a[8:11]
  ds_read_b128 a[208:211], v198 offset:32768
  v_cvt_pk_bf16_f32 v133, v102, v103
  v_mfma_f32_16x16x32_bf16 a[40:43], a[232:235], v[140:143], a[40:43]
  ds_read_b128 a[212:215], v198 offset:36864
  v_cvt_pk_bf16_f32 v134, v108, v109
  v_mfma_f32_16x16x32_bf16 a[12:15], a[236:239], v[136:139], a[12:15]
  ds_read_b128 a[216:219], v199 offset:32768
  v_mfma_f32_16x16x32_bf16 a[44:47], a[236:239], v[140:143], a[44:47]
  ds_read_b128 a[220:223], v199 offset:36864
  v_mfma_f32_16x16x32_bf16 a[16:19], a[240:243], v[136:139], a[16:19]
  s_add_u32 m0, s43, 16384
  s_nop 0
  buffer_load_dwordx4 v224, s[12:15], s39 offen offset:0 nt lds
  v_mfma_f32_16x16x32_bf16 a[48:51], a[240:243], v[140:143], a[48:51]
  buffer_load_dwordx4 v225, s[12:15], s39 offen offset:1024 nt lds
  v_mfma_f32_16x16x32_bf16 a[20:23], a[244:247], v[136:139], a[20:23]
  buffer_load_dwordx4 v224, s[12:15], s39 offen offset:2048 nt lds
  v_mfma_f32_16x16x32_bf16 a[52:55], a[244:247], v[140:143], a[52:55]
  buffer_load_dwordx4 v225, s[12:15], s39 offen offset:3072 nt lds
  v_mfma_f32_16x16x32_bf16 a[24:27], a[248:251], v[136:139], a[24:27]
  s_add_u32 s39, s39, 16384
  v_mfma_f32_16x16x32_bf16 a[56:59], a[248:251], v[140:143], a[56:59]
  v_exp_f32 v111, v111
  v_mfma_f32_16x16x32_bf16 a[28:31], a[252:255], v[136:139], a[28:31]
  v_cvt_pk_bf16_f32 v135, v110, v111
  v_mfma_f32_16x16x32_bf16 a[60:63], a[252:255], v[140:143], a[60:63]
  v_mfma_f32_16x16x32_bf16 v[168:171], v[192:195], v[136:139], v[168:171]
  v_mfma_f32_16x16x32_bf16 v[172:175], v[192:195], v[140:143], v[172:175]
  s_waitcnt lgkmcnt(0)
  v_mfma_f32_16x16x32_bf16 v[96:99], a[192:195], v[0:3], v[144:147]
  v_exp_f32 v112, v112
  v_mfma_f32_16x16x32_bf16 v[100:103], a[192:195], v[16:19], v[148:151]
  v_exp_f32 v113, v113
  v_mfma_f32_16x16x32_bf16 v[104:107], a[196:199], v[0:3], v[144:147]
  v_exp_f32 v114, v114
  v_mfma_f32_16x16x32_bf16 v[108:111], a[196:199], v[16:19], v[148:151]
  v_exp_f32 v115, v115
  v_mfma_f32_16x16x32_bf16 v[96:99], a[200:203], v[4:7], v[96:99]
  v_exp_f32 v120, v120
  v_mfma_f32_16x16x32_bf16 v[100:103], a[200:203], v[20:23], v[100:103]
  v_exp_f32 v121, v121
  v_mfma_f32_16x16x32_bf16 v[104:107], a[204:207], v[4:7], v[104:107]
  v_exp_f32 v122, v122
  v_mfma_f32_16x16x32_bf16 v[108:111], a[204:207], v[20:23], v[108:111]
  v_exp_f32 v123, v123
  v_mfma_f32_16x16x32_bf16 v[96:99], a[208:211], v[8:11], v[96:99]
  v_exp_f32 v116, v116
  v_mfma_f32_16x16x32_bf16 v[100:103], a[208:211], v[24:27], v[100:103]
  v_exp_f32 v117, v117
  v_mfma_f32_16x16x32_bf16 v[104:107], a[212:215], v[8:11], v[104:107]
  v_exp_f32 v118, v118
  v_mfma_f32_16x16x32_bf16 v[108:111], a[212:215], v[24:27], v[108:111]
  v_exp_f32 v119, v119
  v_mfma_f32_16x16x32_bf16 v[96:99], a[216:219], v[12:15], v[96:99]
  v_exp_f32 v124, v124
  v_mfma_f32_16x16x32_bf16 v[100:103], a[216:219], v[28:31], v[100:103]
  v_exp_f32 v125, v125
  v_mfma_f32_16x16x32_bf16 v[104:107], a[220:223], v[12:15], v[104:107]
  v_exp_f32 v126, v126
  v_mfma_f32_16x16x32_bf16 v[108:111], a[220:223], v[28:31], v[108:111]
  v_exp_f32 v127, v127
  v_mfma_f32_16x16x32_bf16 a[64:67], a[224:227], v[128:131], a[64:67]
  v_cvt_pk_bf16_f32 v136, v112, v113
  v_cvt_pk_bf16_f32 v137, v114, v115
  v_mfma_f32_16x16x32_bf16 a[96:99], a[224:227], v[132:135], a[96:99]
  v_cvt_pk_bf16_f32 v138, v120, v121
  v_cvt_pk_bf16_f32 v139, v122, v123
  v_mfma_f32_16x16x32_bf16 a[68:71], a[228:231], v[128:131], a[68:71]
  v_cvt_pk_bf16_f32 v140, v116, v117
  v_cvt_pk_bf16_f32 v141, v118, v119
  v_mfma_f32_16x16x32_bf16 a[100:103], a[228:231], v[132:135], a[100:103]
  v_cvt_pk_bf16_f32 v142, v124, v125
  v_cvt_pk_bf16_f32 v143, v126, v127
  v_mfma_f32_16x16x32_bf16 a[72:75], a[232:235], v[128:131], a[72:75]
  v_mfma_f32_16x16x32_bf16 a[104:107], a[232:235], v[132:135], a[104:107]
  v_mfma_f32_16x16x32_bf16 a[76:79], a[236:239], v[128:131], a[76:79]
  v_mfma_f32_16x16x32_bf16 a[108:111], a[236:239], v[132:135], a[108:111]
  v_mfma_f32_16x16x32_bf16 a[80:83], a[240:243], v[128:131], a[80:83]
  v_mfma_f32_16x16x32_bf16 a[112:115], a[240:243], v[132:135], a[112:115]
  v_mfma_f32_16x16x32_bf16 a[84:87], a[244:247], v[128:131], a[84:87]
  v_mfma_f32_16x16x32_bf16 a[116:119], a[244:247], v[132:135], a[116:119]
  v_mfma_f32_16x16x32_bf16 a[88:91], a[248:251], v[128:131], a[88:91]
  v_mfma_f32_16x16x32_bf16 a[120:123], a[248:251], v[132:135], a[120:123]
  v_mfma_f32_16x16x32_bf16 a[92:95], a[252:255], v[128:131], a[92:95]
  v_mfma_f32_16x16x32_bf16 a[124:127], a[252:255], v[132:135], a[124:127]
  v_mfma_f32_16x16x32_bf16 v[176:179], v[192:195], v[128:131], v[176:179]
  v_mfma_f32_16x16x32_bf16 v[180:183], v[192:195], v[132:135], v[180:183]
  s_waitcnt vmcnt(16)
  s_barrier
  v_mfma_f32_16x16x32_bf16 v[112:115], a[192:195], v[32:35], v[152:155]
  s_add_u32 m0, s43, 32768
  s_nop 0
  buffer_load_dwordx4 v220, s[8:11], s38 offen offset:0 nt lds
  v_mfma_f32_16x16x32_bf16 v[116:119], a[192:195], v[48:51], v[156:159]
  buffer_load_dwordx4 v221, s[8:11], s38 offen offset:1024 nt lds
  v_mfma_f32_16x16x32_bf16 v[120:123], a[196:199], v[32:35], v[152:155]
  buffer_load_dwordx4 v222, s[8:11], s38 offen offset:2048 nt lds
  v_mfma_f32_16x16x32_bf16 v[124:127], a[196:199], v[48:51], v[156:159]
  buffer_load_dwordx4 v223, s[8:11], s38 offen offset:3072 nt lds
  v_mfma_f32_16x16x32_bf16 v[112:115], a[200:203], v[36:39], v[112:115]
  s_add_u32 s38, s38, 16384
  v_mfma_f32_16x16x32_bf16 v[116:119], a[200:203], v[52:55], v[116:119]
  v_exp_f32 v96, v96
  v_mfma_f32_16x16x32_bf16 v[120:123], a[204:207], v[36:39], v[120:123]
  v_exp_f32 v97, v97
  v_mfma_f32_16x16x32_bf16 v[124:127], a[204:207], v[52:55], v[124:127]
  v_exp_f32 v98, v98
  v_mfma_f32_16x16x32_bf16 v[112:115], a[208:211], v[40:43], v[112:115]
  v_exp_f32 v99, v99
  v_mfma_f32_16x16x32_bf16 v[116:119], a[208:211], v[56:59], v[116:119]
  v_exp_f32 v104, v104
  v_mfma_f32_16x16x32_bf16 v[120:123], a[212:215], v[40:43], v[120:123]
  v_exp_f32 v105, v105
  v_mfma_f32_16x16x32_bf16 v[124:127], a[212:215], v[56:59], v[124:127]
  v_exp_f32 v106, v106
  v_mfma_f32_16x16x32_bf16 v[112:115], a[216:219], v[44:47], v[112:115]
  v_exp_f32 v107, v107
  v_mfma_f32_16x16x32_bf16 v[116:119], a[216:219], v[60:63], v[116:119]
  v_exp_f32 v100, v100
  v_mfma_f32_16x16x32_bf16 v[120:123], a[220:223], v[44:47], v[120:123]
  v_exp_f32 v101, v101
  v_mfma_f32_16x16x32_bf16 v[124:127], a[220:223], v[60:63], v[124:127]
  v_exp_f32 v102, v102
  v_mfma_f32_16x16x32_bf16 a[128:131], a[224:227], v[136:139], a[128:131]
  v_exp_f32 v103, v103
  v_mfma_f32_16x16x32_bf16 a[160:163], a[224:227], v[140:143], a[160:163]
  ds_read_b64_tr_b16 a[224:225], v212 offset:0
  ds_read_b64_tr_b16 a[226:227], v212 offset:4096
  v_mfma_f32_16x16x32_bf16 a[132:135], a[228:231], v[136:139], a[132:135]
  v_exp_f32 v108, v108
  v_mfma_f32_16x16x32_bf16 a[164:167], a[228:231], v[140:143], a[164:167]
  ds_read_b64_tr_b16 a[228:229], v213 offset:0
  ds_read_b64_tr_b16 a[230:231], v213 offset:4096
  v_mfma_f32_16x16x32_bf16 a[136:139], a[232:235], v[136:139], a[136:139]
  v_exp_f32 v109, v109
  v_mfma_f32_16x16x32_bf16 a[168:171], a[232:235], v[140:143], a[168:171]
  ds_read_b64_tr_b16 a[232:233], v214 offset:0
  ds_read_b64_tr_b16 a[234:235], v214 offset:4096
  v_mfma_f32_16x16x32_bf16 a[140:143], a[236:239], v[136:139], a[140:143]
  v_exp_f32 v110, v110
  v_mfma_f32_16x16x32_bf16 a[172:175], a[236:239], v[140:143], a[172:175]
  ds_read_b64_tr_b16 a[236:237], v215 offset:0
  ds_read_b64_tr_b16 a[238:239], v215 offset:4096
  v_mfma_f32_16x16x32_bf16 a[144:147], a[240:243], v[136:139], a[144:147]
  v_exp_f32 v111, v111
  v_mfma_f32_16x16x32_bf16 a[176:179], a[240:243], v[140:143], a[176:179]
  ds_read_b64_tr_b16 a[240:241], v216 offset:0
  ds_read_b64_tr_b16 a[242:243], v216 offset:4096
  v_mfma_f32_16x16x32_bf16 a[148:151], a[244:247], v[136:139], a[148:151]
  v_cvt_pk_bf16_f32 v128, v96, v97
  v_cvt_pk_bf16_f32 v129, v98, v99
  v_mfma_f32_16x16x32_bf16 a[180:183], a[244:247], v[140:143], a[180:183]
  ds_read_b64_tr_b16 a[244:245], v217 offset:0
  ds_read_b64_tr_b16 a[246:247], v217 offset:4096
  v_mfma_f32_16x16x32_bf16 a[152:155], a[248:251], v[136:139], a[152:155]
  v_cvt_pk_bf16_f32 v130, v104, v105
  v_cvt_pk_bf16_f32 v131, v106, v107
  v_mfma_f32_16x16x32_bf16 a[184:187], a[248:251], v[140:143], a[184:187]
  ds_read_b64_tr_b16 a[248:249], v218 offset:0
  ds_read_b64_tr_b16 a[250:251], v218 offset:4096
  v_mfma_f32_16x16x32_bf16 a[156:159], a[252:255], v[136:139], a[156:159]
  v_cvt_pk_bf16_f32 v132, v100, v101
  v_cvt_pk_bf16_f32 v133, v102, v103
  v_mfma_f32_16x16x32_bf16 a[188:191], a[252:255], v[140:143], a[188:191]
  ds_read_b64_tr_b16 a[252:253], v219 offset:0
  ds_read_b64_tr_b16 a[254:255], v219 offset:4096
  v_mfma_f32_16x16x32_bf16 v[184:187], v[192:195], v[136:139], v[184:187]
  v_cvt_pk_bf16_f32 v134, v108, v109
  v_cvt_pk_bf16_f32 v135, v110, v111
  v_mfma_f32_16x16x32_bf16 v[188:191], v[192:195], v[140:143], v[188:191]
  v_mfma_f32_16x16x32_bf16 v[96:99], a[192:195], v[64:67], v[160:163]
  v_exp_f32 v112, v112
  v_mfma_f32_16x16x32_bf16 v[100:103], a[192:195], v[80:83], v[164:167]
  v_exp_f32 v113, v113
  v_mfma_f32_16x16x32_bf16 v[104:107], a[196:199], v[64:67], v[160:163]
  v_exp_f32 v114, v114
  v_mfma_f32_16x16x32_bf16 v[108:111], a[196:199], v[80:83], v[164:167]
  v_exp_f32 v115, v115
  v_mfma_f32_16x16x32_bf16 v[96:99], a[200:203], v[68:71], v[96:99]
  v_exp_f32 v120, v120
  v_mfma_f32_16x16x32_bf16 v[100:103], a[200:203], v[84:87], v[100:103]
  v_exp_f32 v121, v121
  v_mfma_f32_16x16x32_bf16 v[104:107], a[204:207], v[68:71], v[104:107]
  v_exp_f32 v122, v122
  v_mfma_f32_16x16x32_bf16 v[108:111], a[204:207], v[84:87], v[108:111]
  v_exp_f32 v123, v123
  v_mfma_f32_16x16x32_bf16 v[96:99], a[208:211], v[72:75], v[96:99]
  v_exp_f32 v116, v116
  v_mfma_f32_16x16x32_bf16 v[100:103], a[208:211], v[88:91], v[100:103]
  v_exp_f32 v117, v117
  v_mfma_f32_16x16x32_bf16 v[104:107], a[212:215], v[72:75], v[104:107]
  v_exp_f32 v118, v118
  v_mfma_f32_16x16x32_bf16 v[108:111], a[212:215], v[88:91], v[108:111]
  v_exp_f32 v119, v119
  v_mfma_f32_16x16x32_bf16 v[96:99], a[216:219], v[76:79], v[96:99]
  v_exp_f32 v124, v124
  v_mfma_f32_16x16x32_bf16 v[100:103], a[216:219], v[92:95], v[100:103]
  v_exp_f32 v125, v125
  v_mfma_f32_16x16x32_bf16 v[104:107], a[220:223], v[76:79], v[104:107]
  v_exp_f32 v126, v126
  v_mfma_f32_16x16x32_bf16 v[108:111], a[220:223], v[92:95], v[108:111]
  s_waitcnt lgkmcnt(0)
  v_cvt_pk_bf16_f32 v136, v112, v113
  v_mfma_f32_16x16x32_bf16 a[0:3], a[224:227], v[128:131], a[0:3]
  ds_read_b128 a[192:195], v200 offset:0
  v_cvt_pk_bf16_f32 v137, v114, v115
  v_mfma_f32_16x16x32_bf16 a[32:35], a[224:227], v[132:135], a[32:35]
  ds_read_b128 a[196:199], v200 offset:4096
  v_cvt_pk_bf16_f32 v138, v120, v121
  v_mfma_f32_16x16x32_bf16 a[4:7], a[228:231], v[128:131], a[4:7]
  ds_read_b128 a[200:203], v201 offset:0
  v_cvt_pk_bf16_f32 v139, v122, v123
  v_mfma_f32_16x16x32_bf16 a[36:39], a[228:231], v[132:135], a[36:39]
  ds_read_b128 a[204:207], v201 offset:4096
  v_cvt_pk_bf16_f32 v140, v116, v117
  v_mfma_f32_16x16x32_bf16 a[8:11], a[232:235], v[128:131], a[8:11]
  ds_read_b128 a[208:211], v202 offset:0
  v_cvt_pk_bf16_f32 v141, v118, v119
  v_mfma_f32_16x16x32_bf16 a[40:43], a[232:235], v[132:135], a[40:43]
  ds_read_b128 a[212:215], v202 offset:4096
  v_cvt_pk_bf16_f32 v142, v124, v125
  v_mfma_f32_16x16x32_bf16 a[12:15], a[236:239], v[128:131], a[12:15]
  ds_read_b128 a[216:219], v203 offset:0
  v_mfma_f32_16x16x32_bf16 a[44:47], a[236:239], v[132:135], a[44:47]
  ds_read_b128 a[220:223], v203 offset:4096
  v_mfma_f32_16x16x32_bf16 a[16:19], a[240:243], v[128:131], a[16:19]
  s_add_u32 m0, s43, 49152
  s_nop 0
  buffer_load_dwordx4 v224, s[12:15], s39 offen offset:0 nt lds
  v_mfma_f32_16x16x32_bf16 a[48:51], a[240:243], v[132:135], a[48:51]
  buffer_load_dwordx4 v225, s[12:15], s39 offen offset:1024 nt lds
  v_mfma_f32_16x16x32_bf16 a[20:23], a[244:247], v[128:131], a[20:23]
  buffer_load_dwordx4 v224, s[12:15], s39 offen offset:2048 nt lds
  v_mfma_f32_16x16x32_bf16 a[52:55], a[244:247], v[132:135], a[52:55]
  buffer_load_dwordx4 v225, s[12:15], s39 offen offset:3072 nt lds
  v_mfma_f32_16x16x32_bf16 a[24:27], a[248:251], v[128:131], a[24:27]
  s_add_u32 s39, s39, 16384
  v_mfma_f32_16x16x32_bf16 a[56:59], a[248:251], v[132:135], a[56:59]
  v_exp_f32 v127, v127
  v_mfma_f32_16x16x32_bf16 a[28:31], a[252:255], v[128:131], a[28:31]
  v_cvt_pk_bf16_f32 v143, v126, v127
  v_mfma_f32_16x16x32_bf16 a[60:63], a[252:255], v[132:135], a[60:63]
  v_mfma_f32_16x16x32_bf16 v[168:171], v[192:195], v[128:131], v[168:171]
  v_mfma_f32_16x16x32_bf16 v[172:175], v[192:195], v[132:135], v[172:175]
  s_waitcnt lgkmcnt(0)
  v_mfma_f32_16x16x32_bf16 v[112:115], a[192:195], v[0:3], v[144:147]
  v_exp_f32 v96, v96
  v_mfma_f32_16x16x32_bf16 v[116:119], a[192:195], v[16:19], v[148:151]
  v_exp_f32 v97, v97
  v_mfma_f32_16x16x32_bf16 v[120:123], a[196:199], v[0:3], v[144:147]
  v_exp_f32 v98, v98
  v_mfma_f32_16x16x32_bf16 v[124:127], a[196:199], v[16:19], v[148:151]
  v_exp_f32 v99, v99
  v_mfma_f32_16x16x32_bf16 v[112:115], a[200:203], v[4:7], v[112:115]
  v_exp_f32 v104, v104
  v_mfma_f32_16x16x32_bf16 v[116:119], a[200:203], v[20:23], v[116:119]
  v_exp_f32 v105, v105
  v_mfma_f32_16x16x32_bf16 v[120:123], a[204:207], v[4:7], v[120:123]
  v_exp_f32 v106, v106
  v_mfma_f32_16x16x32_bf16 v[124:127], a[204:207], v[20:23], v[124:127]
  v_exp_f32 v107, v107
  v_mfma_f32_16x16x32_bf16 v[112:115], a[208:211], v[8:11], v[112:115]
  v_exp_f32 v100, v100
  v_mfma_f32_16x16x32_bf16 v[116:119], a[208:211], v[24:27], v[116:119]
  v_exp_f32 v101, v101
  v_mfma_f32_16x16x32_bf16 v[120:123], a[212:215], v[8:11], v[120:123]
  v_exp_f32 v102, v102
  v_mfma_f32_16x16x32_bf16 v[124:127], a[212:215], v[24:27], v[124:127]
  v_exp_f32 v103, v103
  v_mfma_f32_16x16x32_bf16 v[112:115], a[216:219], v[12:15], v[112:115]
  v_exp_f32 v108, v108
  v_mfma_f32_16x16x32_bf16 v[116:119], a[216:219], v[28:31], v[116:119]
  v_exp_f32 v109, v109
  v_mfma_f32_16x16x32_bf16 v[120:123], a[220:223], v[12:15], v[120:123]
  v_exp_f32 v110, v110
  v_mfma_f32_16x16x32_bf16 v[124:127], a[220:223], v[28:31], v[124:127]
  v_exp_f32 v111, v111
  v_mfma_f32_16x16x32_bf16 a[64:67], a[224:227], v[136:139], a[64:67]
  v_cvt_pk_bf16_f32 v128, v96, v97
  v_cvt_pk_bf16_f32 v129, v98, v99
  v_mfma_f32_16x16x32_bf16 a[96:99], a[224:227], v[140:143], a[96:99]
  v_cvt_pk_bf16_f32 v130, v104, v105
  v_cvt_pk_bf16_f32 v131, v106, v107
  v_mfma_f32_16x16x32_bf16 a[68:71], a[228:231], v[136:139], a[68:71]
  v_cvt_pk_bf16_f32 v132, v100, v101
  v_cvt_pk_bf16_f32 v133, v102, v103
  v_mfma_f32_16x16x32_bf16 a[100:103], a[228:231], v[140:143], a[100:103]
  v_cvt_pk_bf16_f32 v134, v108, v109
  v_cvt_pk_bf16_f32 v135, v110, v111
  v_mfma_f32_16x16x32_bf16 a[72:75], a[232:235], v[136:139], a[72:75]
  v_mfma_f32_16x16x32_bf16 a[104:107], a[232:235], v[140:143], a[104:107]
  v_mfma_f32_16x16x32_bf16 a[76:79], a[236:239], v[136:139], a[76:79]
  v_mfma_f32_16x16x32_bf16 a[108:111], a[236:239], v[140:143], a[108:111]
  v_mfma_f32_16x16x32_bf16 a[80:83], a[240:243], v[136:139], a[80:83]
  v_mfma_f32_16x16x32_bf16 a[112:115], a[240:243], v[140:143], a[112:115]
  v_mfma_f32_16x16x32_bf16 a[84:87], a[244:247], v[136:139], a[84:87]
  v_mfma_f32_16x16x32_bf16 a[116:119], a[244:247], v[140:143], a[116:119]
  v_mfma_f32_16x16x32_bf16 a[88:91], a[248:251], v[136:139], a[88:91]
  v_mfma_f32_16x16x32_bf16 a[120:123], a[248:251], v[140:143], a[120:123]
  v_mfma_f32_16x16x32_bf16 a[92:95], a[252:255], v[136:139], a[92:95]
  v_mfma_f32_16x16x32_bf16 a[124:127], a[252:255], v[140:143], a[124:127]
  v_mfma_f32_16x16x32_bf16 v[176:179], v[192:195], v[136:139], v[176:179]
  v_mfma_f32_16x16x32_bf16 v[180:183], v[192:195], v[140:143], v[180:183]
  s_waitcnt vmcnt(16)
  s_barrier
  v_mfma_f32_16x16x32_bf16 v[96:99], a[192:195], v[32:35], v[152:155]
  s_add_u32 m0, s43, 65536
  s_nop 0
  buffer_load_dwordx4 v220, s[8:11], s38 offen offset:0 nt lds
  v_mfma_f32_16x16x32_bf16 v[100:103], a[192:195], v[48:51], v[156:159]
  buffer_load_dwordx4 v221, s[8:11], s38 offen offset:1024 nt lds
  v_mfma_f32_16x16x32_bf16 v[104:107], a[196:199], v[32:35], v[152:155]
  buffer_load_dwordx4 v222, s[8:11], s38 offen offset:2048 nt lds
  v_mfma_f32_16x16x32_bf16 v[108:111], a[196:199], v[48:51], v[156:159]
  buffer_load_dwordx4 v223, s[8:11], s38 offen offset:3072 nt lds
  v_mfma_f32_16x16x32_bf16 v[96:99], a[200:203], v[36:39], v[96:99]
  s_add_u32 s38, s38, 16384
  v_mfma_f32_16x16x32_bf16 v[100:103], a[200:203], v[52:55], v[100:103]
  v_exp_f32 v112, v112
  v_mfma_f32_16x16x32_bf16 v[104:107], a[204:207], v[36:39], v[104:107]
  v_exp_f32 v113, v113
  v_mfma_f32_16x16x32_bf16 v[108:111], a[204:207], v[52:55], v[108:111]
  v_exp_f32 v114, v114
  v_mfma_f32_16x16x32_bf16 v[96:99], a[208:211], v[40:43], v[96:99]
  v_exp_f32 v115, v115
  v_mfma_f32_16x16x32_bf16 v[100:103], a[208:211], v[56:59], v[100:103]
  v_exp_f32 v120, v120
  v_mfma_f32_16x16x32_bf16 v[104:107], a[212:215], v[40:43], v[104:107]
  v_exp_f32 v121, v121
  v_mfma_f32_16x16x32_bf16 v[108:111], a[212:215], v[56:59], v[108:111]
  v_exp_f32 v122, v122
  v_mfma_f32_16x16x32_bf16 v[96:99], a[216:219], v[44:47], v[96:99]
  v_exp_f32 v123, v123
  v_mfma_f32_16x16x32_bf16 v[100:103], a[216:219], v[60:63], v[100:103]
  v_exp_f32 v116, v116
  v_mfma_f32_16x16x32_bf16 v[104:107], a[220:223], v[44:47], v[104:107]
  v_exp_f32 v117, v117
  v_mfma_f32_16x16x32_bf16 v[108:111], a[220:223], v[60:63], v[108:111]
  v_exp_f32 v118, v118
  v_mfma_f32_16x16x32_bf16 a[128:131], a[224:227], v[128:131], a[128:131]
  v_exp_f32 v119, v119
  v_mfma_f32_16x16x32_bf16 a[160:163], a[224:227], v[132:135], a[160:163]
  ds_read_b64_tr_b16 a[224:225], v212 offset:32768
  ds_read_b64_tr_b16 a[226:227], v212 offset:36864
  v_mfma_f32_16x16x32_bf16 a[132:135], a[228:231], v[128:131], a[132:135]
  v_exp_f32 v124, v124
  v_mfma_f32_16x16x32_bf16 a[164:167], a[228:231], v[132:135], a[164:167]
  ds_read_b64_tr_b16 a[228:229], v213 offset:32768
  ds_read_b64_tr_b16 a[230:231], v213 offset:36864
  v_mfma_f32_16x16x32_bf16 a[136:139], a[232:235], v[128:131], a[136:139]
  v_exp_f32 v125, v125
  v_mfma_f32_16x16x32_bf16 a[168:171], a[232:235], v[132:135], a[168:171]
  ds_read_b64_tr_b16 a[232:233], v214 offset:32768
  ds_read_b64_tr_b16 a[234:235], v214 offset:36864
  v_mfma_f32_16x16x32_bf16 a[140:143], a[236:239], v[128:131], a[140:143]
  v_exp_f32 v126, v126
  v_mfma_f32_16x16x32_bf16 a[172:175], a[236:239], v[132:135], a[172:175]
  ds_read_b64_tr_b16 a[236:237], v215 offset:32768
  ds_read_b64_tr_b16 a[238:239], v215 offset:36864
  v_mfma_f32_16x16x32_bf16 a[144:147], a[240:243], v[128:131], a[144:147]
  v_exp_f32 v127, v127
  v_mfma_f32_16x16x32_bf16 a[176:179], a[240:243], v[132:135], a[176:179]
  ds_read_b64_tr_b16 a[240:241], v216 offset:32768
  ds_read_b64_tr_b16 a[242:243], v216 offset:36864
  v_mfma_f32_16x16x32_bf16 a[148:151], a[244:247], v[128:131], a[148:151]
  v_cvt_pk_bf16_f32 v136, v112, v113
  v_cvt_pk_bf16_f32 v137, v114, v115
  v_mfma_f32_16x16x32_bf16 a[180:183], a[244:247], v[132:135], a[180:183]
  ds_read_b64_tr_b16 a[244:245], v217 offset:32768
  ds_read_b64_tr_b16 a[246:247], v217 offset:36864
  v_mfma_f32_16x16x32_bf16 a[152:155], a[248:251], v[128:131], a[152:155]
  v_cvt_pk_bf16_f32 v138, v120, v121
  v_cvt_pk_bf16_f32 v139, v122, v123
  v_mfma_f32_16x16x32_bf16 a[184:187], a[248:251], v[132:135], a[184:187]
  ds_read_b64_tr_b16 a[248:249], v218 offset:32768
  ds_read_b64_tr_b16 a[250:251], v218 offset:36864
  v_mfma_f32_16x16x32_bf16 a[156:159], a[252:255], v[128:131], a[156:159]
  v_cvt_pk_bf16_f32 v140, v116, v117
  v_cvt_pk_bf16_f32 v141, v118, v119
  v_mfma_f32_16x16x32_bf16 a[188:191], a[252:255], v[132:135], a[188:191]
  ds_read_b64_tr_b16 a[252:253], v219 offset:32768
  ds_read_b64_tr_b16 a[254:255], v219 offset:36864
  v_mfma_f32_16x16x32_bf16 v[184:187], v[192:195], v[128:131], v[184:187]
  v_cvt_pk_bf16_f32 v142, v124, v125
  v_cvt_pk_bf16_f32 v143, v126, v127
  v_mfma_f32_16x16x32_bf16 v[188:191], v[192:195], v[132:135], v[188:191]
  v_mfma_f32_16x16x32_bf16 v[112:115], a[192:195], v[64:67], v[160:163]
  v_exp_f32 v96, v96
  v_mfma_f32_16x16x32_bf16 v[116:119], a[192:195], v[80:83], v[164:167]
  v_exp_f32 v97, v97
  v_mfma_f32_16x16x32_bf16 v[120:123], a[196:199], v[64:67], v[160:163]
  v_exp_f32 v98, v98
  v_mfma_f32_16x16x32_bf16 v[124:127], a[196:199], v[80:83], v[164:167]
  v_exp_f32 v99, v99
  v_mfma_f32_16x16x32_bf16 v[112:115], a[200:203], v[68:71], v[112:115]
  v_exp_f32 v104, v104
  v_mfma_f32_16x16x32_bf16 v[116:119], a[200:203], v[84:87], v[116:119]
  v_exp_f32 v105, v105
  v_mfma_f32_16x16x32_bf16 v[120:123], a[204:207], v[68:71], v[120:123]
  v_exp_f32 v106, v106
  v_mfma_f32_16x16x32_bf16 v[124:127], a[204:207], v[84:87], v[124:127]
  v_exp_f32 v107, v107
  v_mfma_f32_16x16x32_bf16 v[112:115], a[208:211], v[72:75], v[112:115]
  v_exp_f32 v100, v100
  v_mfma_f32_16x16x32_bf16 v[116:119], a[208:211], v[88:91], v[116:119]
  v_exp_f32 v101, v101
  v_mfma_f32_16x16x32_bf16 v[120:123], a[212:215], v[72:75], v[120:123]
  v_exp_f32 v102, v102
  v_mfma_f32_16x16x32_bf16 v[124:127], a[212:215], v[88:91], v[124:127]
  v_exp_f32 v103, v103
  v_mfma_f32_16x16x32_bf16 v[112:115], a[216:219], v[76:79], v[112:115]
  v_exp_f32 v108, v108
  v_mfma_f32_16x16x32_bf16 v[116:119], a[216:219], v[92:95], v[116:119]
  v_exp_f32 v109, v109
  v_mfma_f32_16x16x32_bf16 v[120:123], a[220:223], v[76:79], v[120:123]
  v_exp_f32 v110, v110
  v_mfma_f32_16x16x32_bf16 v[124:127], a[220:223], v[92:95], v[124:127]
  s_waitcnt lgkmcnt(0)
  v_cvt_pk_bf16_f32 v128, v96, v97
  v_mfma_f32_16x16x32_bf16 a[0:3], a[224:227], v[136:139], a[0:3]
  ds_read_b128 a[192:195], v200 offset:32768
  v_cvt_pk_bf16_f32 v129, v98, v99
  v_mfma_f32_16x16x32_bf16 a[32:35], a[224:227], v[140:143], a[32:35]
  ds_read_b128 a[196:199], v200 offset:36864
  v_cvt_pk_bf16_f32 v130, v104, v105
  v_mfma_f32_16x16x32_bf16 a[4:7], a[228:231], v[136:139], a[4:7]
  ds_read_b128 a[200:203], v201 offset:32768
  v_cvt_pk_bf16_f32 v131, v106, v107
  v_mfma_f32_16x16x32_bf16 a[36:39], a[228:231], v[140:143], a[36:39]
  ds_read_b128 a[204:207], v201 offset:36864
  v_cvt_pk_bf16_f32 v132, v100, v101
  v_mfma_f32_16x16x32_bf16 a[8:11], a[232:235], v[136:139], a[8:11]
  ds_read_b128 a[208:211], v202 offset:32768
  v_cvt_pk_bf16_f32 v133, v102, v103
  v_mfma_f32_16x16x32_bf16 a[40:43], a[232:235], v[140:143], a[40:43]
  ds_read_b128 a[212:215], v202 offset:36864
  v_cvt_pk_bf16_f32 v134, v108, v109
  v_mfma_f32_16x16x32_bf16 a[12:15], a[236:239], v[136:139], a[12:15]
  ds_read_b128 a[216:219], v203 offset:32768
  v_mfma_f32_16x16x32_bf16 a[44:47], a[236:239], v[140:143], a[44:47]
  ds_read_b128 a[220:223], v203 offset:36864
  v_mfma_f32_16x16x32_bf16 a[16:19], a[240:243], v[136:139], a[16:19]
  s_add_u32 m0, s43, 81920
  s_nop 0
  buffer_load_dwordx4 v224, s[12:15], s39 offen offset:0 nt lds
  v_mfma_f32_16x16x32_bf16 a[48:51], a[240:243], v[140:143], a[48:51]
  buffer_load_dwordx4 v225, s[12:15], s39 offen offset:1024 nt lds
  v_mfma_f32_16x16x32_bf16 a[20:23], a[244:247], v[136:139], a[20:23]
  buffer_load_dwordx4 v224, s[12:15], s39 offen offset:2048 nt lds
  v_mfma_f32_16x16x32_bf16 a[52:55], a[244:247], v[140:143], a[52:55]
  buffer_load_dwordx4 v225, s[12:15], s39 offen offset:3072 nt lds
  v_mfma_f32_16x16x32_bf16 a[24:27], a[248:251], v[136:139], a[24:27]
  s_add_u32 s39, s39, 16384
  v_mfma_f32_16x16x32_bf16 a[56:59], a[248:251], v[140:143], a[56:59]
  v_exp_f32 v111, v111
  v_mfma_f32_16x16x32_bf16 a[28:31], a[252:255], v[136:139], a[28:31]
  v_cvt_pk_bf16_f32 v135, v110, v111
  v_mfma_f32_16x16x32_bf16 a[60:63], a[252:255], v[140:143], a[60:63]
  v_mfma_f32_16x16x32_bf16 v[168:171], v[192:195], v[136:139], v[168:171]
  v_mfma_f32_16x16x32_bf16 v[172:175], v[192:195], v[140:143], v[172:175]
  s_waitcnt lgkmcnt(0)
  v_mfma_f32_16x16x32_bf16 v[96:99], a[192:195], v[0:3], v[144:147]
  v_exp_f32 v112, v112
  v_mfma_f32_16x16x32_bf16 v[100:103], a[192:195], v[16:19], v[148:151]
  v_exp_f32 v113, v113
  v_mfma_f32_16x16x32_bf16 v[104:107], a[196:199], v[0:3], v[144:147]
  v_exp_f32 v114, v114
  v_mfma_f32_16x16x32_bf16 v[108:111], a[196:199], v[16:19], v[148:151]
  v_exp_f32 v115, v115
  v_mfma_f32_16x16x32_bf16 v[96:99], a[200:203], v[4:7], v[96:99]
  v_exp_f32 v120, v120
  v_mfma_f32_16x16x32_bf16 v[100:103], a[200:203], v[20:23], v[100:103]
  v_exp_f32 v121, v121
  v_mfma_f32_16x16x32_bf16 v[104:107], a[204:207], v[4:7], v[104:107]
  v_exp_f32 v122, v122
  v_mfma_f32_16x16x32_bf16 v[108:111], a[204:207], v[20:23], v[108:111]
  v_exp_f32 v123, v123
  v_mfma_f32_16x16x32_bf16 v[96:99], a[208:211], v[8:11], v[96:99]
  v_exp_f32 v116, v116
  v_mfma_f32_16x16x32_bf16 v[100:103], a[208:211], v[24:27], v[100:103]
  v_exp_f32 v117, v117
  v_mfma_f32_16x16x32_bf16 v[104:107], a[212:215], v[8:11], v[104:107]
  v_exp_f32 v118, v118
  v_mfma_f32_16x16x32_bf16 v[108:111], a[212:215], v[24:27], v[108:111]
  v_exp_f32 v119, v119
  v_mfma_f32_16x16x32_bf16 v[96:99], a[216:219], v[12:15], v[96:99]
  v_exp_f32 v124, v124
  v_mfma_f32_16x16x32_bf16 v[100:103], a[216:219], v[28:31], v[100:103]
  v_exp_f32 v125, v125
  v_mfma_f32_16x16x32_bf16 v[104:107], a[220:223], v[12:15], v[104:107]
  v_exp_f32 v126, v126
  v_mfma_f32_16x16x32_bf16 v[108:111], a[220:223], v[28:31], v[108:111]
  v_exp_f32 v127, v127
  v_mfma_f32_16x16x32_bf16 a[64:67], a[224:227], v[128:131], a[64:67]
  v_cvt_pk_bf16_f32 v136, v112, v113
  v_cvt_pk_bf16_f32 v137, v114, v115
  v_mfma_f32_16x16x32_bf16 a[96:99], a[224:227], v[132:135], a[96:99]
  v_cvt_pk_bf16_f32 v138, v120, v121
  v_cvt_pk_bf16_f32 v139, v122, v123
  v_mfma_f32_16x16x32_bf16 a[68:71], a[228:231], v[128:131], a[68:71]
  v_cvt_pk_bf16_f32 v140, v116, v117
  v_cvt_pk_bf16_f32 v141, v118, v119
  v_mfma_f32_16x16x32_bf16 a[100:103], a[228:231], v[132:135], a[100:103]
  v_cvt_pk_bf16_f32 v142, v124, v125
  v_cvt_pk_bf16_f32 v143, v126, v127
  v_mfma_f32_16x16x32_bf16 a[72:75], a[232:235], v[128:131], a[72:75]
  v_mfma_f32_16x16x32_bf16 a[104:107], a[232:235], v[132:135], a[104:107]
  v_mfma_f32_16x16x32_bf16 a[76:79], a[236:239], v[128:131], a[76:79]
  v_mfma_f32_16x16x32_bf16 a[108:111], a[236:239], v[132:135], a[108:111]
  v_mfma_f32_16x16x32_bf16 a[80:83], a[240:243], v[128:131], a[80:83]
  v_mfma_f32_16x16x32_bf16 a[112:115], a[240:243], v[132:135], a[112:115]
  v_mfma_f32_16x16x32_bf16 a[84:87], a[244:247], v[128:131], a[84:87]
  v_mfma_f32_16x16x32_bf16 a[116:119], a[244:247], v[132:135], a[116:119]
  v_mfma_f32_16x16x32_bf16 a[88:91], a[248:251], v[128:131], a[88:91]
  v_mfma_f32_16x16x32_bf16 a[120:123], a[248:251], v[132:135], a[120:123]
  v_mfma_f32_16x16x32_bf16 a[92:95], a[252:255], v[128:131], a[92:95]
  v_mfma_f32_16x16x32_bf16 a[124:127], a[252:255], v[132:135], a[124:127]
  v_mfma_f32_16x16x32_bf16 v[176:179], v[192:195], v[128:131], v[176:179]
  v_mfma_f32_16x16x32_bf16 v[180:183], v[192:195], v[132:135], v[180:183]
  s_add_u32 s40, s40, 1
  s_cmp_lt_u32 s40, 8
  s_cbranch_scc1 L_loop
  v_mfma_f32_16x16x32_bf16 a[128:131], a[224:227], v[136:139], a[128:131]
  v_mfma_f32_16x16x32_bf16 a[160:163], a[224:227], v[140:143], a[160:163]
  v_mfma_f32_16x16x32_bf16 a[132:135], a[228:231], v[136:139], a[132:135]
  v_mfma_f32_16x16x32_bf16 a[164:167], a[228:231], v[140:143], a[164:167]
  v_mfma_f32_16x16x32_bf16 a[136:139], a[232:235], v[136:139], a[136:139]
  v_mfma_f32_16x16x32_bf16 a[168:171], a[232:235], v[140:143], a[168:171]
  v_mfma_f32_16x16x32_bf16 a[140:143], a[236:239], v[136:139], a[140:143]
  v_mfma_f32_16x16x32_bf16 a[172:175], a[236:239], v[140:143], a[172:175]
  v_mfma_f32_16x16x32_bf16 a[144:147], a[240:243], v[136:139], a[144:147]
  v_mfma_f32_16x16x32_bf16 a[176:179], a[240:243], v[140:143], a[176:179]
  v_mfma_f32_16x16x32_bf16 a[148:151], a[244:247], v[136:139], a[148:151]
  v_mfma_f32_16x16x32_bf16 a[180:183], a[244:247], v[140:143], a[180:183]
  v_mfma_f32_16x16x32_bf16 a[152:155], a[248:251], v[136:139], a[152:155]
  v_mfma_f32_16x16x32_bf16 a[184:187], a[248:251], v[140:143], a[184:187]
  v_mfma_f32_16x16x32_bf16 a[156:159], a[252:255], v[136:139], a[156:159]
  v_mfma_f32_16x16x32_bf16 a[188:191], a[252:255], v[140:143], a[188:191]
  v_mfma_f32_16x16x32_bf16 v[184:187], v[192:195], v[136:139], v[184:187]
  v_mfma_f32_16x16x32_bf16 v[188:191], v[192:195], v[140:143], v[188:191]
  v_lshrrev_b32 v228, 2, v226
  s_mul_i32 s44, s3, 3072
  s_add_u32 s44, s44, 131072
  v_add_u32 v229, s44, v228
  s_xor_b32 s45, s3, 2
  s_mul_i32 s44, s45, 3072
  s_add_u32 s44, s44, 131072
  v_add_u32 v230, s44, v228
  s_nop 4
  ds_write_b32 v229, v144 offset:0
  ds_write_b32 v229, v168 offset:256
  ds_write_b32 v229, v148 offset:512
  ds_write_b32 v229, v172 offset:768
  ds_write_b32 v229, v152 offset:1024
  ds_write_b32 v229, v176 offset:1280
  ds_write_b32 v229, v156 offset:1536
  ds_write_b32 v229, v180 offset:1792
  ds_write_b32 v229, v160 offset:2048
  ds_write_b32 v229, v184 offset:2304
  ds_write_b32 v229, v164 offset:2560
  ds_write_b32 v229, v188 offset:2816
  s_waitcnt vmcnt(0)
  s_cmp_eq_u32 s92, 99
  s_cbranch_scc1 L_notkw
  v_readfirstlane_b32 s44, v248
  v_mov_b32 v249, 163792
  s_nop 1
  v_mov_b32 v247, s44
  ds_write_b32 v249, v247
L_notkw:
  s_waitcnt vmcnt(0) lgkmcnt(0)
  s_barrier
  v_mov_b32 v249, 163792
  ds_read_b32 v248, v249
  ds_read_b32 v96, v230 offset:0
  ds_read_b32 v97, v230 offset:256
  ds_read_b32 v98, v230 offset:512
  ds_read_b32 v99, v230 offset:768
  ds_read_b32 v100, v230 offset:1024
  ds_read_b32 v101, v230 offset:1280
  ds_read_b32 v102, v230 offset:1536
  ds_read_b32 v103, v230 offset:1792
  ds_read_b32 v104, v230 offset:2048
  ds_read_b32 v105, v230 offset:2304
  ds_read_b32 v106, v230 offset:2560
  ds_read_b32 v107, v230 offset:2816
  s_mov_b32 s84, s58
  s_and_b32 s85, s59, 0xffff
  s_mov_b32 s86, 4718592
  s_mov_b32 s87, 0x20000
  s_mul_i32 s44, s2, 18432
  s_mul_i32 s45, s3, 4608
  s_add_u32 s44, s44, s45
  buffer_load_dwordx4 v[252:255], v226, s[84:87], s44 offen offset:0
  buffer_load_dwordx4 v[252:255], v226, s[84:87], s44 offen offset:1024
  buffer_load_dwordx4 v[252:255], v226, s[84:87], s44 offen offset:2048
  buffer_load_dwordx4 v[252:255], v226, s[84:87], s44 offen offset:3072
  buffer_load_dwordx4 v[252:255], v226, s[84:87], s44 offen offset:3584
  s_mul_i32 s44, s3, 24576
  v_add_u32 v236, s44, v226
  s_xor_b32 s45, s3, 2
  s_mul_i32 s44, s45, 24576
  v_add_u32 v237, s44, v226
  s_mul_i32 s44, s36, 6
  s_mul_i32 s45, s34, 12
  s_add_u32 s44, s44, s45
  s_lshl_b32 s44, s44, 5
  s_add_u32 s44, s44, s35
  s_lshl_b32 s46, s44, 12
  s_mov_b32 s24, s32
  s_and_b32 s25, s33, 0xffff
  s_mov_b32 s26, 12582912
  s_mov_b32 s27, 0x20000
  s_waitcnt lgkmcnt(12)
  s_cmp_eq_u32 s41, 0
  s_cbranch_scc0 L_havetk
  v_readfirstlane_b32 s93, v248
L_havetk:
  s_cmp_eq_u32 s37, 0
  s_cbranch_scc0 L_ep1
  ds_write_b128 v236, a[16:19] offset:0
  ds_write_b128 v236, a[20:23] offset:1024
  ds_write_b128 v236, a[24:27] offset:2048
  ds_write_b128 v236, a[28:31] offset:3072
  ds_write_b128 v236, a[48:51] offset:4096
  ds_write_b128 v236, a[52:55] offset:5120
  ds_write_b128 v236, a[56:59] offset:6144
  ds_write_b128 v236, a[60:63] offset:7168
  ds_write_b128 v236, a[80:83] offset:8192
  ds_write_b128 v236, a[84:87] offset:9216
  ds_write_b128 v236, a[88:91] offset:10240
  ds_write_b128 v236, a[92:95] offset:11264
  v_add_f32 v234, v168, v172
  v_add_f32 v234, v234, v176
  v_add_f32 v234, v234, v180
  v_add_f32 v234, v234, v184
  v_add_f32 v234, v234, v188
  s_waitcnt lgkmcnt(12)
  ds_write_b128 v236, a[112:115] offset:12288
  v_min_f32 v128, v144, v96
  v_min_f32 v129, v148, v98
  v_min_f32 v130, v152, v100
  ds_write_b128 v236, a[116:119] offset:13312
  v_min_f32 v131, v156, v102
  v_min_f32 v132, v160, v104
  v_min_f32 v133, v164, v106
  ds_write_b128 v236, a[120:123] offset:14336
  v_sub_f32 v134, v128, v144
  v_sub_f32 v135, v129, v148
  v_sub_f32 v136, v130, v152
  ds_write_b128 v236, a[124:127] offset:15360
  v_sub_f32 v137, v131, v156
  v_sub_f32 v138, v132, v160
  v_sub_f32 v139, v133, v164
  ds_write_b128 v236, a[144:147] offset:16384
  v_sub_f32 v108, v128, v96
  v_sub_f32 v109, v129, v98
  v_sub_f32 v110, v130, v100
  ds_write_b128 v236, a[148:151] offset:17408
  v_sub_f32 v111, v131, v102
  v_sub_f32 v112, v132, v104
  v_sub_f32 v113, v133, v106
  ds_write_b128 v236, a[152:155] offset:18432
  v_exp_f32 v134, v134
  v_exp_f32 v135, v135
  v_exp_f32 v136, v136
  ds_write_b128 v236, a[156:159] offset:19456
  v_exp_f32 v137, v137
  v_exp_f32 v138, v138
  v_exp_f32 v139, v139
  ds_write_b128 v236, a[176:179] offset:20480
  v_exp_f32 v108, v108
  v_exp_f32 v109, v109
  v_exp_f32 v110, v110
  ds_write_b128 v236, a[180:183] offset:21504
  v_exp_f32 v111, v111
  v_exp_f32 v112, v112
  v_exp_f32 v113, v113
  ds_write_b128 v236, a[184:187] offset:22528
  v_mul_f32 v128, v168, v134
  v_mul_f32 v129, v172, v135
  v_mul_f32 v130, v176, v136
  ds_write_b128 v236, a[188:191] offset:23552
  v_mul_f32 v131, v180, v137
  v_mul_f32 v132, v184, v138
  v_mul_f32 v133, v188, v139
  v_fma_f32 v128, v97, v108, v128
  v_fma_f32 v129, v99, v109, v129
  v_fma_f32 v130, v101, v110, v130
  v_fma_f32 v131, v103, v111, v131
  v_fma_f32 v132, v105, v112, v132
  v_fma_f32 v133, v107, v113, v133
  v_rcp_f32 v128, v128
  v_rcp_f32 v129, v129
  v_rcp_f32 v130, v130
  v_rcp_f32 v131, v131
  v_rcp_f32 v132, v132
  v_rcp_f32 v133, v133
  s_nop 0
  v_mul_f32 v144, v134, v128
  v_mul_f32 v148, v135, v129
  v_mul_f32 v152, v136, v130
  v_mul_f32 v156, v137, v131
  v_mul_f32 v160, v138, v132
  v_mul_f32 v164, v139, v133
  v_mul_f32 v146, v108, v128
  v_mul_f32 v150, v109, v129
  v_mul_f32 v154, v110, v130
  v_mul_f32 v158, v111, v131
  v_mul_f32 v162, v112, v132
  v_mul_f32 v166, v113, v133
  s_waitcnt lgkmcnt(0)
  s_barrier
  ds_read_b128 v[0:3], v237 offset:0
  ds_read_b128 v[4:7], v237 offset:1024
  ds_read_b128 v[8:11], v237 offset:2048
  ds_read_b128 v[12:15], v237 offset:3072
  ds_read_b128 v[16:19], v237 offset:4096
  ds_read_b128 v[20:23], v237 offset:5120
  ds_read_b128 v[24:27], v237 offset:6144
  ds_read_b128 v[28:31], v237 offset:7168
  ds_read_b128 v[32:35], v237 offset:8192
  ds_read_b128 v[36:39], v237 offset:9216
  ds_read_b128 v[40:43], v237 offset:10240
  ds_read_b128 v[44:47], v237 offset:11264
  ds_read_b128 v[48:51], v237 offset:12288
  ds_read_b128 v[52:55], v237 offset:13312
  ds_read_b128 v[56:59], v237 offset:14336
  ds_read_b128 v[60:63], v237 offset:15360
  ds_read_b128 v[64:67], v237 offset:16384
  ds_read_b128 v[68:71], v237 offset:17408
  ds_read_b128 v[72:75], v237 offset:18432
  ds_read_b128 v[76:79], v237 offset:19456
  ds_read_b128 v[80:83], v237 offset:20480
  ds_read_b128 v[84:87], v237 offset:21504
  ds_read_b128 v[88:91], v237 offset:22528
  ds_read_b128 v[92:95], v237 offset:23552
  v_mov_b32 v238, 0
  v_mov_b32 v239, 0
  v_accvgpr_read_b32 v96, a0
  v_accvgpr_read_b32 v97, a1
  v_accvgpr_read_b32 v98, a2
  v_accvgpr_read_b32 v99, a3
  v_accvgpr_read_b32 v100, a4
  v_accvgpr_read_b32 v101, a5
  v_accvgpr_read_b32 v102, a6
  v_accvgpr_read_b32 v103, a7
  v_accvgpr_read_b32 v104, a8
  v_accvgpr_read_b32 v105, a9
  v_accvgpr_read_b32 v106, a10
  v_accvgpr_read_b32 v107, a11
  v_accvgpr_read_b32 v108, a12
  v_accvgpr_read_b32 v109, a13
  v_accvgpr_read_b32 v110, a14
  v_accvgpr_read_b32 v111, a15
  s_waitcnt lgkmcnt(15)
  v_pk_mul_f32 v[0:1], v[0:1], v[146:147] op_sel_hi:[1,0]
  v_pk_mul_f32 v[2:3], v[2:3], v[146:147] op_sel_hi:[1,0]
  v_pk_mul_f32 v[4:5], v[4:5], v[146:147] op_sel_hi:[1,0]
  v_pk_mul_f32 v[6:7], v[6:7], v[146:147] op_sel_hi:[1,0]
  v_pk_mul_f32 v[8:9], v[8:9], v[146:147] op_sel_hi:[1,0]
  v_pk_mul_f32 v[10:11], v[10:11], v[146:147] op_sel_hi:[1,0]
  v_pk_mul_f32 v[12:13], v[12:13], v[146:147] op_sel_hi:[1,0]
  v_pk_mul_f32 v[14:15], v[14:15], v[146:147] op_sel_hi:[1,0]
  v_pk_fma_f32 v[0:1], v[96:97], v[144:145], v[0:1] op_sel_hi:[1,0,1]
  v_pk_fma_f32 v[2:3], v[98:99], v[144:145], v[2:3] op_sel_hi:[1,0,1]
  v_pk_fma_f32 v[4:5], v[100:101], v[144:145], v[4:5] op_sel_hi:[1,0,1]
  v_pk_fma_f32 v[6:7], v[102:103], v[144:145], v[6:7] op_sel_hi:[1,0,1]
  v_pk_fma_f32 v[8:9], v[104:105], v[144:145], v[8:9] op_sel_hi:[1,0,1]
  v_pk_fma_f32 v[10:11], v[106:107], v[144:145], v[10:11] op_sel_hi:[1,0,1]
  v_pk_fma_f32 v[12:13], v[108:109], v[144:145], v[12:13] op_sel_hi:[1,0,1]
  v_pk_fma_f32 v[14:15], v[110:111], v[144:145], v[14:15] op_sel_hi:[1,0,1]
  v_cvt_pk_bf16_f32 v96, v0, v1
  v_cvt_pk_bf16_f32 v97, v2, v3
  v_cvt_pk_bf16_f32 v98, v4, v5
  v_cvt_pk_bf16_f32 v99, v6, v7
  v_cvt_pk_bf16_f32 v100, v8, v9
  v_cvt_pk_bf16_f32 v101, v10, v11
  v_cvt_pk_bf16_f32 v102, v12, v13
  v_cvt_pk_bf16_f32 v103, v14, v15
  s_add_u32 s44, s46, 0
  buffer_store_dwordx4 v[96:99], v226, s[24:27], s44 offen sc1
  s_add_u32 s44, s46, 1024
  buffer_store_dwordx4 v[100:103], v226, s[24:27], s44 offen sc1
  v_pk_add_f32 v[238:239], v[238:239], v[0:1]
  v_pk_add_f32 v[238:239], v[238:239], v[2:3]
  v_pk_add_f32 v[238:239], v[238:239], v[4:5]
  v_pk_add_f32 v[238:239], v[238:239], v[6:7]
  v_pk_add_f32 v[238:239], v[238:239], v[8:9]
  v_pk_add_f32 v[238:239], v[238:239], v[10:11]
  v_pk_add_f32 v[238:239], v[238:239], v[12:13]
  v_pk_add_f32 v[238:239], v[238:239], v[14:15]
  v_accvgpr_read_b32 v112, a32
  v_accvgpr_read_b32 v113, a33
  v_accvgpr_read_b32 v114, a34
  v_accvgpr_read_b32 v115, a35
  v_accvgpr_read_b32 v116, a36
  v_accvgpr_read_b32 v117, a37
  v_accvgpr_read_b32 v118, a38
  v_accvgpr_read_b32 v119, a39
  v_accvgpr_read_b32 v120, a40
  v_accvgpr_read_b32 v121, a41
  v_accvgpr_read_b32 v122, a42
  v_accvgpr_read_b32 v123, a43
  v_accvgpr_read_b32 v124, a44
  v_accvgpr_read_b32 v125, a45
  v_accvgpr_read_b32 v126, a46
  v_accvgpr_read_b32 v127, a47
  s_waitcnt lgkmcnt(15)
  v_pk_mul_f32 v[16:17], v[16:17], v[150:151] op_sel_hi:[1,0]
  v_pk_mul_f32 v[18:19], v[18:19], v[150:151] op_sel_hi:[1,0]
  v_pk_mul_f32 v[20:21], v[20:21], v[150:151] op_sel_hi:[1,0]
  v_pk_mul_f32 v[22:23], v[22:23], v[150:151] op_sel_hi:[1,0]
  v_pk_mul_f32 v[24:25], v[24:25], v[150:151] op_sel_hi:[1,0]
  v_pk_mul_f32 v[26:27], v[26:27], v[150:151] op_sel_hi:[1,0]
  v_pk_mul_f32 v[28:29], v[28:29], v[150:151] op_sel_hi:[1,0]
  v_pk_mul_f32 v[30:31], v[30:31], v[150:151] op_sel_hi:[1,0]
  v_pk_fma_f32 v[16:17], v[112:113], v[148:149], v[16:17] op_sel_hi:[1,0,1]
  v_pk_fma_f32 v[18:19], v[114:115], v[148:149], v[18:19] op_sel_hi:[1,0,1]
  v_pk_fma_f32 v[20:21], v[116:117], v[148:149], v[20:21] op_sel_hi:[1,0,1]
  v_pk_fma_f32 v[22:23], v[118:119], v[148:149], v[22:23] op_sel_hi:[1,0,1]
  v_pk_fma_f32 v[24:25], v[120:121], v[148:149], v[24:25] op_sel_hi:[1,0,1]
  v_pk_fma_f32 v[26:27], v[122:123], v[148:149], v[26:27] op_sel_hi:[1,0,1]
  v_pk_fma_f32 v[28:29], v[124:125], v[148:149], v[28:29] op_sel_hi:[1,0,1]
  v_pk_fma_f32 v[30:31], v[126:127], v[148:149], v[30:31] op_sel_hi:[1,0,1]
  v_cvt_pk_bf16_f32 v112, v16, v17
  v_cvt_pk_bf16_f32 v113, v18, v19
  v_cvt_pk_bf16_f32 v114, v20, v21
  v_cvt_pk_bf16_f32 v115, v22, v23
  v_cvt_pk_bf16_f32 v116, v24, v25
  v_cvt_pk_bf16_f32 v117, v26, v27
  v_cvt_pk_bf16_f32 v118, v28, v29
  v_cvt_pk_bf16_f32 v119, v30, v31
  s_add_u32 s44, s46, 131072
  buffer_store_dwordx4 v[112:115], v226, s[24:27], s44 offen sc1
  s_add_u32 s44, s46, 132096
  buffer_store_dwordx4 v[116:119], v226, s[24:27], s44 offen sc1
  v_pk_add_f32 v[238:239], v[238:239], v[16:17]
  v_pk_add_f32 v[238:239], v[238:239], v[18:19]
  v_pk_add_f32 v[238:239], v[238:239], v[20:21]
  v_pk_add_f32 v[238:239], v[238:239], v[22:23]
  v_pk_add_f32 v[238:239], v[238:239], v[24:25]
  v_pk_add_f32 v[238:239], v[238:239], v[26:27]
  v_pk_add_f32 v[238:239], v[238:239], v[28:29]
  v_pk_add_f32 v[238:239], v[238:239], v[30:31]
  v_accvgpr_read_b32 v96, a64
  v_accvgpr_read_b32 v97, a65
  v_accvgpr_read_b32 v98, a66
  v_accvgpr_read_b32 v99, a67
  v_accvgpr_read_b32 v100, a68
  v_accvgpr_read_b32 v101, a69
  v_accvgpr_read_b32 v102, a70
  v_accvgpr_read_b32 v103, a71
  v_accvgpr_read_b32 v104, a72
  v_accvgpr_read_b32 v105, a73
  v_accvgpr_read_b32 v106, a74
  v_accvgpr_read_b32 v107, a75
  v_accvgpr_read_b32 v108, a76
  v_accvgpr_read_b32 v109, a77
  v_accvgpr_read_b32 v110, a78
  v_accvgpr_read_b32 v111, a79
  s_waitcnt lgkmcnt(12)
  v_pk_mul_f32 v[32:33], v[32:33], v[154:155] op_sel_hi:[1,0]
  v_pk_mul_f32 v[34:35], v[34:35], v[154:155] op_sel_hi:[1,0]
  v_pk_mul_f32 v[36:37], v[36:37], v[154:155] op_sel_hi:[1,0]
  v_pk_mul_f32 v[38:39], v[38:39], v[154:155] op_sel_hi:[1,0]
  v_pk_mul_f32 v[40:41], v[40:41], v[154:155] op_sel_hi:[1,0]
  v_pk_mul_f32 v[42:43], v[42:43], v[154:155] op_sel_hi:[1,0]
  v_pk_mul_f32 v[44:45], v[44:45], v[154:155] op_sel_hi:[1,0]
  v_pk_mul_f32 v[46:47], v[46:47], v[154:155] op_sel_hi:[1,0]
  v_pk_fma_f32 v[32:33], v[96:97], v[152:153], v[32:33] op_sel_hi:[1,0,1]
  v_pk_fma_f32 v[34:35], v[98:99], v[152:153], v[34:35] op_sel_hi:[1,0,1]
  v_pk_fma_f32 v[36:37], v[100:101], v[152:153], v[36:37] op_sel_hi:[1,0,1]
  v_pk_fma_f32 v[38:39], v[102:103], v[152:153], v[38:39] op_sel_hi:[1,0,1]
  v_pk_fma_f32 v[40:41], v[104:105], v[152:153], v[40:41] op_sel_hi:[1,0,1]
  v_pk_fma_f32 v[42:43], v[106:107], v[152:153], v[42:43] op_sel_hi:[1,0,1]
  v_pk_fma_f32 v[44:45], v[108:109], v[152:153], v[44:45] op_sel_hi:[1,0,1]
  v_pk_fma_f32 v[46:47], v[110:111], v[152:153], v[46:47] op_sel_hi:[1,0,1]
  v_cvt_pk_bf16_f32 v96, v32, v33
  v_cvt_pk_bf16_f32 v97, v34, v35
  v_cvt_pk_bf16_f32 v98, v36, v37
  v_cvt_pk_bf16_f32 v99, v38, v39
  v_cvt_pk_bf16_f32 v100, v40, v41
  v_cvt_pk_bf16_f32 v101, v42, v43
  v_cvt_pk_bf16_f32 v102, v44, v45
  v_cvt_pk_bf16_f32 v103, v46, v47
  s_add_u32 s44, s46, 262144
  buffer_store_dwordx4 v[96:99], v226, s[24:27], s44 offen sc1
  s_add_u32 s44, s46, 263168
  buffer_store_dwordx4 v[100:103], v226, s[24:27], s44 offen sc1
  v_pk_add_f32 v[238:239], v[238:239], v[32:33]
  v_pk_add_f32 v[238:239], v[238:239], v[34:35]
  v_pk_add_f32 v[238:239], v[238:239], v[36:37]
  v_pk_add_f32 v[238:239], v[238:239], v[38:39]
  v_pk_add_f32 v[238:239], v[238:239], v[40:41]
  v_pk_add_f32 v[238:239], v[238:239], v[42:43]
  v_pk_add_f32 v[238:239], v[238:239], v[44:45]
  v_pk_add_f32 v[238:239], v[238:239], v[46:47]
  v_accvgpr_read_b32 v112, a96
  v_accvgpr_read_b32 v113, a97
  v_accvgpr_read_b32 v114, a98
  v_accvgpr_read_b32 v115, a99
  v_accvgpr_read_b32 v116, a100
  v_accvgpr_read_b32 v117, a101
  v_accvgpr_read_b32 v118, a102
  v_accvgpr_read_b32 v119, a103
  v_accvgpr_read_b32 v120, a104
  v_accvgpr_read_b32 v121, a105
  v_accvgpr_read_b32 v122, a106
  v_accvgpr_read_b32 v123, a107
  v_accvgpr_read_b32 v124, a108
  v_accvgpr_read_b32 v125, a109
  v_accvgpr_read_b32 v126, a110
  v_accvgpr_read_b32 v127, a111
  s_waitcnt lgkmcnt(8)
  v_pk_mul_f32 v[48:49], v[48:49], v[158:159] op_sel_hi:[1,0]
  v_pk_mul_f32 v[50:51], v[50:51], v[158:159] op_sel_hi:[1,0]
  v_pk_mul_f32 v[52:53], v[52:53], v[158:159] op_sel_hi:[1,0]
  v_pk_mul_f32 v[54:55], v[54:55], v[158:159] op_sel_hi:[1,0]
  v_pk_mul_f32 v[56:57], v[56:57], v[158:159] op_sel_hi:[1,0]
  v_pk_mul_f32 v[58:59], v[58:59], v[158:159] op_sel_hi:[1,0]
  v_pk_mul_f32 v[60:61], v[60:61], v[158:159] op_sel_hi:[1,0]
  v_pk_mul_f32 v[62:63], v[62:63], v[158:159] op_sel_hi:[1,0]
  v_pk_fma_f32 v[48:49], v[112:113], v[156:157], v[48:49] op_sel_hi:[1,0,1]
  v_pk_fma_f32 v[50:51], v[114:115], v[156:157], v[50:51] op_sel_hi:[1,0,1]
  v_pk_fma_f32 v[52:53], v[116:117], v[156:157], v[52:53] op_sel_hi:[1,0,1]
  v_pk_fma_f32 v[54:55], v[118:119], v[156:157], v[54:55] op_sel_hi:[1,0,1]
  v_pk_fma_f32 v[56:57], v[120:121], v[156:157], v[56:57] op_sel_hi:[1,0,1]
  v_pk_fma_f32 v[58:59], v[122:123], v[156:157], v[58:59] op_sel_hi:[1,0,1]
  v_pk_fma_f32 v[60:61], v[124:125], v[156:157], v[60:61] op_sel_hi:[1,0,1]
  v_pk_fma_f32 v[62:63], v[126:127], v[156:157], v[62:63] op_sel_hi:[1,0,1]
  v_cvt_pk_bf16_f32 v112, v48, v49
  v_cvt_pk_bf16_f32 v113, v50, v51
  v_cvt_pk_bf16_f32 v114, v52, v53
  v_cvt_pk_bf16_f32 v115, v54, v55
  v_cvt_pk_bf16_f32 v116, v56, v57
  v_cvt_pk_bf16_f32 v117, v58, v59
  v_cvt_pk_bf16_f32 v118, v60, v61
  v_cvt_pk_bf16_f32 v119, v62, v63
  s_add_u32 s44, s46, 393216
  buffer_store_dwordx4 v[112:115], v226, s[24:27], s44 offen sc1
  s_add_u32 s44, s46, 394240
  buffer_store_dwordx4 v[116:119], v226, s[24:27], s44 offen sc1
  v_pk_add_f32 v[238:239], v[238:239], v[48:49]
  v_pk_add_f32 v[238:239], v[238:239], v[50:51]
  v_pk_add_f32 v[238:239], v[238:239], v[52:53]
  v_pk_add_f32 v[238:239], v[238:239], v[54:55]
  v_pk_add_f32 v[238:239], v[238:239], v[56:57]
  v_pk_add_f32 v[238:239], v[238:239], v[58:59]
  v_pk_add_f32 v[238:239], v[238:239], v[60:61]
  v_pk_add_f32 v[238:239], v[238:239], v[62:63]
  v_accvgpr_read_b32 v96, a128
  v_accvgpr_read_b32 v97, a129
  v_accvgpr_read_b32 v98, a130
  v_accvgpr_read_b32 v99, a131
  v_accvgpr_read_b32 v100, a132
  v_accvgpr_read_b32 v101, a133
  v_accvgpr_read_b32 v102, a134
  v_accvgpr_read_b32 v103, a135
  v_accvgpr_read_b32 v104, a136
  v_accvgpr_read_b32 v105, a137
  v_accvgpr_read_b32 v106, a138
  v_accvgpr_read_b32 v107, a139
  v_accvgpr_read_b32 v108, a140
  v_accvgpr_read_b32 v109, a141
  v_accvgpr_read_b32 v110, a142
  v_accvgpr_read_b32 v111, a143
  s_waitcnt lgkmcnt(4)
  v_pk_mul_f32 v[64:65], v[64:65], v[162:163] op_sel_hi:[1,0]
  v_pk_mul_f32 v[66:67], v[66:67], v[162:163] op_sel_hi:[1,0]
  v_pk_mul_f32 v[68:69], v[68:69], v[162:163] op_sel_hi:[1,0]
  v_pk_mul_f32 v[70:71], v[70:71], v[162:163] op_sel_hi:[1,0]
  v_pk_mul_f32 v[72:73], v[72:73], v[162:163] op_sel_hi:[1,0]
  v_pk_mul_f32 v[74:75], v[74:75], v[162:163] op_sel_hi:[1,0]
  v_pk_mul_f32 v[76:77], v[76:77], v[162:163] op_sel_hi:[1,0]
  v_pk_mul_f32 v[78:79], v[78:79], v[162:163] op_sel_hi:[1,0]
  v_pk_fma_f32 v[64:65], v[96:97], v[160:161], v[64:65] op_sel_hi:[1,0,1]
  v_pk_fma_f32 v[66:67], v[98:99], v[160:161], v[66:67] op_sel_hi:[1,0,1]
  v_pk_fma_f32 v[68:69], v[100:101], v[160:161], v[68:69] op_sel_hi:[1,0,1]
  v_pk_fma_f32 v[70:71], v[102:103], v[160:161], v[70:71] op_sel_hi:[1,0,1]
  v_pk_fma_f32 v[72:73], v[104:105], v[160:161], v[72:73] op_sel_hi:[1,0,1]
  v_pk_fma_f32 v[74:75], v[106:107], v[160:161], v[74:75] op_sel_hi:[1,0,1]
  v_pk_fma_f32 v[76:77], v[108:109], v[160:161], v[76:77] op_sel_hi:[1,0,1]
  v_pk_fma_f32 v[78:79], v[110:111], v[160:161], v[78:79] op_sel_hi:[1,0,1]
  v_cvt_pk_bf16_f32 v96, v64, v65
  v_cvt_pk_bf16_f32 v97, v66, v67
  v_cvt_pk_bf16_f32 v98, v68, v69
  v_cvt_pk_bf16_f32 v99, v70, v71
  v_cvt_pk_bf16_f32 v100, v72, v73
  v_cvt_pk_bf16_f32 v101, v74, v75
  v_cvt_pk_bf16_f32 v102, v76, v77
  v_cvt_pk_bf16_f32 v103, v78, v79
  s_add_u32 s44, s46, 524288
  buffer_store_dwordx4 v[96:99], v226, s[24:27], s44 offen sc1
  s_add_u32 s44, s46, 525312
  buffer_store_dwordx4 v[100:103], v226, s[24:27], s44 offen sc1
  v_pk_add_f32 v[238:239], v[238:239], v[64:65]
  v_pk_add_f32 v[238:239], v[238:239], v[66:67]
  v_pk_add_f32 v[238:239], v[238:239], v[68:69]
  v_pk_add_f32 v[238:239], v[238:239], v[70:71]
  v_pk_add_f32 v[238:239], v[238:239], v[72:73]
  v_pk_add_f32 v[238:239], v[238:239], v[74:75]
  v_pk_add_f32 v[238:239], v[238:239], v[76:77]
  v_pk_add_f32 v[238:239], v[238:239], v[78:79]
  v_accvgpr_read_b32 v112, a160
  v_accvgpr_read_b32 v113, a161
  v_accvgpr_read_b32 v114, a162
  v_accvgpr_read_b32 v115, a163
  v_accvgpr_read_b32 v116, a164
  v_accvgpr_read_b32 v117, a165
  v_accvgpr_read_b32 v118, a166
  v_accvgpr_read_b32 v119, a167
  v_accvgpr_read_b32 v120, a168
  v_accvgpr_read_b32 v121, a169
  v_accvgpr_read_b32 v122, a170
  v_accvgpr_read_b32 v123, a171
  v_accvgpr_read_b32 v124, a172
  v_accvgpr_read_b32 v125, a173
  v_accvgpr_read_b32 v126, a174
  v_accvgpr_read_b32 v127, a175
  s_waitcnt lgkmcnt(0)
  v_pk_mul_f32 v[80:81], v[80:81], v[166:167] op_sel_hi:[1,0]
  v_pk_mul_f32 v[82:83], v[82:83], v[166:167] op_sel_hi:[1,0]
  v_pk_mul_f32 v[84:85], v[84:85], v[166:167] op_sel_hi:[1,0]
  v_pk_mul_f32 v[86:87], v[86:87], v[166:167] op_sel_hi:[1,0]
  v_pk_mul_f32 v[88:89], v[88:89], v[166:167] op_sel_hi:[1,0]
  v_pk_mul_f32 v[90:91], v[90:91], v[166:167] op_sel_hi:[1,0]
  v_pk_mul_f32 v[92:93], v[92:93], v[166:167] op_sel_hi:[1,0]
  v_pk_mul_f32 v[94:95], v[94:95], v[166:167] op_sel_hi:[1,0]
  v_pk_fma_f32 v[80:81], v[112:113], v[164:165], v[80:81] op_sel_hi:[1,0,1]
  v_pk_fma_f32 v[82:83], v[114:115], v[164:165], v[82:83] op_sel_hi:[1,0,1]
  v_pk_fma_f32 v[84:85], v[116:117], v[164:165], v[84:85] op_sel_hi:[1,0,1]
  v_pk_fma_f32 v[86:87], v[118:119], v[164:165], v[86:87] op_sel_hi:[1,0,1]
  v_pk_fma_f32 v[88:89], v[120:121], v[164:165], v[88:89] op_sel_hi:[1,0,1]
  v_pk_fma_f32 v[90:91], v[122:123], v[164:165], v[90:91] op_sel_hi:[1,0,1]
  v_pk_fma_f32 v[92:93], v[124:125], v[164:165], v[92:93] op_sel_hi:[1,0,1]
  v_pk_fma_f32 v[94:95], v[126:127], v[164:165], v[94:95] op_sel_hi:[1,0,1]
  v_cvt_pk_bf16_f32 v112, v80, v81
  v_cvt_pk_bf16_f32 v113, v82, v83
  v_cvt_pk_bf16_f32 v114, v84, v85
  v_cvt_pk_bf16_f32 v115, v86, v87
  v_cvt_pk_bf16_f32 v116, v88, v89
  v_cvt_pk_bf16_f32 v117, v90, v91
  v_cvt_pk_bf16_f32 v118, v92, v93
  v_cvt_pk_bf16_f32 v119, v94, v95
  s_add_u32 s44, s46, 655360
  buffer_store_dwordx4 v[112:115], v226, s[24:27], s44 offen sc1
  s_add_u32 s44, s46, 656384
  buffer_store_dwordx4 v[116:119], v226, s[24:27], s44 offen sc1
  v_pk_add_f32 v[238:239], v[238:239], v[80:81]
  v_pk_add_f32 v[238:239], v[238:239], v[82:83]
  v_pk_add_f32 v[238:239], v[238:239], v[84:85]
  v_pk_add_f32 v[238:239], v[238:239], v[86:87]
  v_pk_add_f32 v[238:239], v[238:239], v[88:89]
  v_pk_add_f32 v[238:239], v[238:239], v[90:91]
  v_pk_add_f32 v[238:239], v[238:239], v[92:93]
  v_pk_add_f32 v[238:239], v[238:239], v[94:95]
  s_branch L_ep_done
L_ep1:
  ds_write_b128 v236, a[0:3] offset:0
  ds_write_b128 v236, a[4:7] offset:1024
  ds_write_b128 v236, a[8:11] offset:2048
  ds_write_b128 v236, a[12:15] offset:3072
  ds_write_b128 v236, a[32:35] offset:4096
  ds_write_b128 v236, a[36:39] offset:5120
  ds_write_b128 v236, a[40:43] offset:6144
  ds_write_b128 v236, a[44:47] offset:7168
  ds_write_b128 v236, a[64:67] offset:8192
  ds_write_b128 v236, a[68:71] offset:9216
  ds_write_b128 v236, a[72:75] offset:10240
  ds_write_b128 v236, a[76:79] offset:11264
  v_add_f32 v234, v168, v172
  v_add_f32 v234, v234, v176
  v_add_f32 v234, v234, v180
  v_add_f32 v234, v234, v184
  v_add_f32 v234, v234, v188
  s_waitcnt lgkmcnt(12)
  ds_write_b128 v236, a[96:99] offset:12288
  v_min_f32 v128, v144, v96
  v_min_f32 v129, v148, v98
  v_min_f32 v130, v152, v100
  ds_write_b128 v236, a[100:103] offset:13312
  v_min_f32 v131, v156, v102
  v_min_f32 v132, v160, v104
  v_min_f32 v133, v164, v106
  ds_write_b128 v236, a[104:107] offset:14336
  v_sub_f32 v134, v128, v144
  v_sub_f32 v135, v129, v148
  v_sub_f32 v136, v130, v152
  ds_write_b128 v236, a[108:111] offset:15360
  v_sub_f32 v137, v131, v156
  v_sub_f32 v138, v132, v160
  v_sub_f32 v139, v133, v164
  ds_write_b128 v236, a[128:131] offset:16384
  v_sub_f32 v108, v128, v96
  v_sub_f32 v109, v129, v98
  v_sub_f32 v110, v130, v100
  ds_write_b128 v236, a[132:135] offset:17408
  v_sub_f32 v111, v131, v102
  v_sub_f32 v112, v132, v104
  v_sub_f32 v113, v133, v106
  ds_write_b128 v236, a[136:139] offset:18432
  v_exp_f32 v134, v134
  v_exp_f32 v135, v135
  v_exp_f32 v136, v136
  ds_write_b128 v236, a[140:143] offset:19456
  v_exp_f32 v137, v137
  v_exp_f32 v138, v138
  v_exp_f32 v139, v139
  ds_write_b128 v236, a[160:163] offset:20480
  v_exp_f32 v108, v108
  v_exp_f32 v109, v109
  v_exp_f32 v110, v110
  ds_write_b128 v236, a[164:167] offset:21504
  v_exp_f32 v111, v111
  v_exp_f32 v112, v112
  v_exp_f32 v113, v113
  ds_write_b128 v236, a[168:171] offset:22528
  v_mul_f32 v128, v168, v134
  v_mul_f32 v129, v172, v135
  v_mul_f32 v130, v176, v136
  ds_write_b128 v236, a[172:175] offset:23552
  v_mul_f32 v131, v180, v137
  v_mul_f32 v132, v184, v138
  v_mul_f32 v133, v188, v139
  v_fma_f32 v128, v97, v108, v128
  v_fma_f32 v129, v99, v109, v129
  v_fma_f32 v130, v101, v110, v130
  v_fma_f32 v131, v103, v111, v131
  v_fma_f32 v132, v105, v112, v132
  v_fma_f32 v133, v107, v113, v133
  v_rcp_f32 v128, v128
  v_rcp_f32 v129, v129
  v_rcp_f32 v130, v130
  v_rcp_f32 v131, v131
  v_rcp_f32 v132, v132
  v_rcp_f32 v133, v133
  s_nop 0
  v_mul_f32 v144, v134, v128
  v_mul_f32 v148, v135, v129
  v_mul_f32 v152, v136, v130
  v_mul_f32 v156, v137, v131
  v_mul_f32 v160, v138, v132
  v_mul_f32 v164, v139, v133
  v_mul_f32 v146, v108, v128
  v_mul_f32 v150, v109, v129
  v_mul_f32 v154, v110, v130
  v_mul_f32 v158, v111, v131
  v_mul_f32 v162, v112, v132
  v_mul_f32 v166, v113, v133
  s_waitcnt lgkmcnt(0)
  s_barrier
  ds_read_b128 v[0:3], v237 offset:0
  ds_read_b128 v[4:7], v237 offset:1024
  ds_read_b128 v[8:11], v237 offset:2048
  ds_read_b128 v[12:15], v237 offset:3072
  ds_read_b128 v[16:19], v237 offset:4096
  ds_read_b128 v[20:23], v237 offset:5120
  ds_read_b128 v[24:27], v237 offset:6144
  ds_read_b128 v[28:31], v237 offset:7168
  ds_read_b128 v[32:35], v237 offset:8192
  ds_read_b128 v[36:39], v237 offset:9216
  ds_read_b128 v[40:43], v237 offset:10240
  ds_read_b128 v[44:47], v237 offset:11264
  ds_read_b128 v[48:51], v237 offset:12288
  ds_read_b128 v[52:55], v237 offset:13312
  ds_read_b128 v[56:59], v237 offset:14336
  ds_read_b128 v[60:63], v237 offset:15360
  ds_read_b128 v[64:67], v237 offset:16384
  ds_read_b128 v[68:71], v237 offset:17408
  ds_read_b128 v[72:75], v237 offset:18432
  ds_read_b128 v[76:79], v237 offset:19456
  ds_read_b128 v[80:83], v237 offset:20480
  ds_read_b128 v[84:87], v237 offset:21504
  ds_read_b128 v[88:91], v237 offset:22528
  ds_read_b128 v[92:95], v237 offset:23552
  v_mov_b32 v238, 0
  v_mov_b32 v239, 0
  v_accvgpr_read_b32 v96, a16
  v_accvgpr_read_b32 v97, a17
  v_accvgpr_read_b32 v98, a18
  v_accvgpr_read_b32 v99, a19
  v_accvgpr_read_b32 v100, a20
  v_accvgpr_read_b32 v101, a21
  v_accvgpr_read_b32 v102, a22
  v_accvgpr_read_b32 v103, a23
  v_accvgpr_read_b32 v104, a24
  v_accvgpr_read_b32 v105, a25
  v_accvgpr_read_b32 v106, a26
  v_accvgpr_read_b32 v107, a27
  v_accvgpr_read_b32 v108, a28
  v_accvgpr_read_b32 v109, a29
  v_accvgpr_read_b32 v110, a30
  v_accvgpr_read_b32 v111, a31
  s_waitcnt lgkmcnt(15)
  v_pk_mul_f32 v[0:1], v[0:1], v[146:147] op_sel_hi:[1,0]
  v_pk_mul_f32 v[2:3], v[2:3], v[146:147] op_sel_hi:[1,0]
  v_pk_mul_f32 v[4:5], v[4:5], v[146:147] op_sel_hi:[1,0]
  v_pk_mul_f32 v[6:7], v[6:7], v[146:147] op_sel_hi:[1,0]
  v_pk_mul_f32 v[8:9], v[8:9], v[146:147] op_sel_hi:[1,0]
  v_pk_mul_f32 v[10:11], v[10:11], v[146:147] op_sel_hi:[1,0]
  v_pk_mul_f32 v[12:13], v[12:13], v[146:147] op_sel_hi:[1,0]
  v_pk_mul_f32 v[14:15], v[14:15], v[146:147] op_sel_hi:[1,0]
  v_pk_fma_f32 v[0:1], v[96:97], v[144:145], v[0:1] op_sel_hi:[1,0,1]
  v_pk_fma_f32 v[2:3], v[98:99], v[144:145], v[2:3] op_sel_hi:[1,0,1]
  v_pk_fma_f32 v[4:5], v[100:101], v[144:145], v[4:5] op_sel_hi:[1,0,1]
  v_pk_fma_f32 v[6:7], v[102:103], v[144:145], v[6:7] op_sel_hi:[1,0,1]
  v_pk_fma_f32 v[8:9], v[104:105], v[144:145], v[8:9] op_sel_hi:[1,0,1]
  v_pk_fma_f32 v[10:11], v[106:107], v[144:145], v[10:11] op_sel_hi:[1,0,1]
  v_pk_fma_f32 v[12:13], v[108:109], v[144:145], v[12:13] op_sel_hi:[1,0,1]
  v_pk_fma_f32 v[14:15], v[110:111], v[144:145], v[14:15] op_sel_hi:[1,0,1]
  v_cvt_pk_bf16_f32 v96, v0, v1
  v_cvt_pk_bf16_f32 v97, v2, v3
  v_cvt_pk_bf16_f32 v98, v4, v5
  v_cvt_pk_bf16_f32 v99, v6, v7
  v_cvt_pk_bf16_f32 v100, v8, v9
  v_cvt_pk_bf16_f32 v101, v10, v11
  v_cvt_pk_bf16_f32 v102, v12, v13
  v_cvt_pk_bf16_f32 v103, v14, v15
  s_add_u32 s44, s46, 2048
  buffer_store_dwordx4 v[96:99], v226, s[24:27], s44 offen sc1
  s_add_u32 s44, s46, 3072
  buffer_store_dwordx4 v[100:103], v226, s[24:27], s44 offen sc1
  v_pk_add_f32 v[238:239], v[238:239], v[0:1]
  v_pk_add_f32 v[238:239], v[238:239], v[2:3]
  v_pk_add_f32 v[238:239], v[238:239], v[4:5]
  v_pk_add_f32 v[238:239], v[238:239], v[6:7]
  v_pk_add_f32 v[238:239], v[238:239], v[8:9]
  v_pk_add_f32 v[238:239], v[238:239], v[10:11]
  v_pk_add_f32 v[238:239], v[238:239], v[12:13]
  v_pk_add_f32 v[238:239], v[238:239], v[14:15]
  v_accvgpr_read_b32 v112, a48
  v_accvgpr_read_b32 v113, a49
  v_accvgpr_read_b32 v114, a50
  v_accvgpr_read_b32 v115, a51
  v_accvgpr_read_b32 v116, a52
  v_accvgpr_read_b32 v117, a53
  v_accvgpr_read_b32 v118, a54
  v_accvgpr_read_b32 v119, a55
  v_accvgpr_read_b32 v120, a56
  v_accvgpr_read_b32 v121, a57
  v_accvgpr_read_b32 v122, a58
  v_accvgpr_read_b32 v123, a59
  v_accvgpr_read_b32 v124, a60
  v_accvgpr_read_b32 v125, a61
  v_accvgpr_read_b32 v126, a62
  v_accvgpr_read_b32 v127, a63
  s_waitcnt lgkmcnt(15)
  v_pk_mul_f32 v[16:17], v[16:17], v[150:151] op_sel_hi:[1,0]
  v_pk_mul_f32 v[18:19], v[18:19], v[150:151] op_sel_hi:[1,0]
  v_pk_mul_f32 v[20:21], v[20:21], v[150:151] op_sel_hi:[1,0]
  v_pk_mul_f32 v[22:23], v[22:23], v[150:151] op_sel_hi:[1,0]
  v_pk_mul_f32 v[24:25], v[24:25], v[150:151] op_sel_hi:[1,0]
  v_pk_mul_f32 v[26:27], v[26:27], v[150:151] op_sel_hi:[1,0]
  v_pk_mul_f32 v[28:29], v[28:29], v[150:151] op_sel_hi:[1,0]
  v_pk_mul_f32 v[30:31], v[30:31], v[150:151] op_sel_hi:[1,0]
  v_pk_fma_f32 v[16:17], v[112:113], v[148:149], v[16:17] op_sel_hi:[1,0,1]
  v_pk_fma_f32 v[18:19], v[114:115], v[148:149], v[18:19] op_sel_hi:[1,0,1]
  v_pk_fma_f32 v[20:21], v[116:117], v[148:149], v[20:21] op_sel_hi:[1,0,1]
  v_pk_fma_f32 v[22:23], v[118:119], v[148:149], v[22:23] op_sel_hi:[1,0,1]
  v_pk_fma_f32 v[24:25], v[120:121], v[148:149], v[24:25] op_sel_hi:[1,0,1]
  v_pk_fma_f32 v[26:27], v[122:123], v[148:149], v[26:27] op_sel_hi:[1,0,1]
  v_pk_fma_f32 v[28:29], v[124:125], v[148:149], v[28:29] op_sel_hi:[1,0,1]
  v_pk_fma_f32 v[30:31], v[126:127], v[148:149], v[30:31] op_sel_hi:[1,0,1]
  v_cvt_pk_bf16_f32 v112, v16, v17
  v_cvt_pk_bf16_f32 v113, v18, v19
  v_cvt_pk_bf16_f32 v114, v20, v21
  v_cvt_pk_bf16_f32 v115, v22, v23
  v_cvt_pk_bf16_f32 v116, v24, v25
  v_cvt_pk_bf16_f32 v117, v26, v27
  v_cvt_pk_bf16_f32 v118, v28, v29
  v_cvt_pk_bf16_f32 v119, v30, v31
  s_add_u32 s44, s46, 133120
  buffer_store_dwordx4 v[112:115], v226, s[24:27], s44 offen sc1
  s_add_u32 s44, s46, 134144
  buffer_store_dwordx4 v[116:119], v226, s[24:27], s44 offen sc1
  v_pk_add_f32 v[238:239], v[238:239], v[16:17]
  v_pk_add_f32 v[238:239], v[238:239], v[18:19]
  v_pk_add_f32 v[238:239], v[238:239], v[20:21]
  v_pk_add_f32 v[238:239], v[238:239], v[22:23]
  v_pk_add_f32 v[238:239], v[238:239], v[24:25]
  v_pk_add_f32 v[238:239], v[238:239], v[26:27]
  v_pk_add_f32 v[238:239], v[238:239], v[28:29]
  v_pk_add_f32 v[238:239], v[238:239], v[30:31]
  v_accvgpr_read_b32 v96, a80
  v_accvgpr_read_b32 v97, a81
  v_accvgpr_read_b32 v98, a82
  v_accvgpr_read_b32 v99, a83
  v_accvgpr_read_b32 v100, a84
  v_accvgpr_read_b32 v101, a85
  v_accvgpr_read_b32 v102, a86
  v_accvgpr_read_b32 v103, a87
  v_accvgpr_read_b32 v104, a88
  v_accvgpr_read_b32 v105, a89
  v_accvgpr_read_b32 v106, a90
  v_accvgpr_read_b32 v107, a91
  v_accvgpr_read_b32 v108, a92
  v_accvgpr_read_b32 v109, a93
  v_accvgpr_read_b32 v110, a94
  v_accvgpr_read_b32 v111, a95
  s_waitcnt lgkmcnt(12)
  v_pk_mul_f32 v[32:33], v[32:33], v[154:155] op_sel_hi:[1,0]
  v_pk_mul_f32 v[34:35], v[34:35], v[154:155] op_sel_hi:[1,0]
  v_pk_mul_f32 v[36:37], v[36:37], v[154:155] op_sel_hi:[1,0]
  v_pk_mul_f32 v[38:39], v[38:39], v[154:155] op_sel_hi:[1,0]
  v_pk_mul_f32 v[40:41], v[40:41], v[154:155] op_sel_hi:[1,0]
  v_pk_mul_f32 v[42:43], v[42:43], v[154:155] op_sel_hi:[1,0]
  v_pk_mul_f32 v[44:45], v[44:45], v[154:155] op_sel_hi:[1,0]
  v_pk_mul_f32 v[46:47], v[46:47], v[154:155] op_sel_hi:[1,0]
  v_pk_fma_f32 v[32:33], v[96:97], v[152:153], v[32:33] op_sel_hi:[1,0,1]
  v_pk_fma_f32 v[34:35], v[98:99], v[152:153], v[34:35] op_sel_hi:[1,0,1]
  v_pk_fma_f32 v[36:37], v[100:101], v[152:153], v[36:37] op_sel_hi:[1,0,1]
  v_pk_fma_f32 v[38:39], v[102:103], v[152:153], v[38:39] op_sel_hi:[1,0,1]
  v_pk_fma_f32 v[40:41], v[104:105], v[152:153], v[40:41] op_sel_hi:[1,0,1]
  v_pk_fma_f32 v[42:43], v[106:107], v[152:153], v[42:43] op_sel_hi:[1,0,1]
  v_pk_fma_f32 v[44:45], v[108:109], v[152:153], v[44:45] op_sel_hi:[1,0,1]
  v_pk_fma_f32 v[46:47], v[110:111], v[152:153], v[46:47] op_sel_hi:[1,0,1]
  v_cvt_pk_bf16_f32 v96, v32, v33
  v_cvt_pk_bf16_f32 v97, v34, v35
  v_cvt_pk_bf16_f32 v98, v36, v37
  v_cvt_pk_bf16_f32 v99, v38, v39
  v_cvt_pk_bf16_f32 v100, v40, v41
  v_cvt_pk_bf16_f32 v101, v42, v43
  v_cvt_pk_bf16_f32 v102, v44, v45
  v_cvt_pk_bf16_f32 v103, v46, v47
  s_add_u32 s44, s46, 264192
  buffer_store_dwordx4 v[96:99], v226, s[24:27], s44 offen sc1
  s_add_u32 s44, s46, 265216
  buffer_store_dwordx4 v[100:103], v226, s[24:27], s44 offen sc1
  v_pk_add_f32 v[238:239], v[238:239], v[32:33]
  v_pk_add_f32 v[238:239], v[238:239], v[34:35]
  v_pk_add_f32 v[238:239], v[238:239], v[36:37]
  v_pk_add_f32 v[238:239], v[238:239], v[38:39]
  v_pk_add_f32 v[238:239], v[238:239], v[40:41]
  v_pk_add_f32 v[238:239], v[238:239], v[42:43]
  v_pk_add_f32 v[238:239], v[238:239], v[44:45]
  v_pk_add_f32 v[238:239], v[238:239], v[46:47]
  v_accvgpr_read_b32 v112, a112
  v_accvgpr_read_b32 v113, a113
  v_accvgpr_read_b32 v114, a114
  v_accvgpr_read_b32 v115, a115
  v_accvgpr_read_b32 v116, a116
  v_accvgpr_read_b32 v117, a117
  v_accvgpr_read_b32 v118, a118
  v_accvgpr_read_b32 v119, a119
  v_accvgpr_read_b32 v120, a120
  v_accvgpr_read_b32 v121, a121
  v_accvgpr_read_b32 v122, a122
  v_accvgpr_read_b32 v123, a123
  v_accvgpr_read_b32 v124, a124
  v_accvgpr_read_b32 v125, a125
  v_accvgpr_read_b32 v126, a126
  v_accvgpr_read_b32 v127, a127
  s_waitcnt lgkmcnt(8)
  v_pk_mul_f32 v[48:49], v[48:49], v[158:159] op_sel_hi:[1,0]
  v_pk_mul_f32 v[50:51], v[50:51], v[158:159] op_sel_hi:[1,0]
  v_pk_mul_f32 v[52:53], v[52:53], v[158:159] op_sel_hi:[1,0]
  v_pk_mul_f32 v[54:55], v[54:55], v[158:159] op_sel_hi:[1,0]
  v_pk_mul_f32 v[56:57], v[56:57], v[158:159] op_sel_hi:[1,0]
  v_pk_mul_f32 v[58:59], v[58:59], v[158:159] op_sel_hi:[1,0]
  v_pk_mul_f32 v[60:61], v[60:61], v[158:159] op_sel_hi:[1,0]
  v_pk_mul_f32 v[62:63], v[62:63], v[158:159] op_sel_hi:[1,0]
  v_pk_fma_f32 v[48:49], v[112:113], v[156:157], v[48:49] op_sel_hi:[1,0,1]
  v_pk_fma_f32 v[50:51], v[114:115], v[156:157], v[50:51] op_sel_hi:[1,0,1]
  v_pk_fma_f32 v[52:53], v[116:117], v[156:157], v[52:53] op_sel_hi:[1,0,1]
  v_pk_fma_f32 v[54:55], v[118:119], v[156:157], v[54:55] op_sel_hi:[1,0,1]
  v_pk_fma_f32 v[56:57], v[120:121], v[156:157], v[56:57] op_sel_hi:[1,0,1]
  v_pk_fma_f32 v[58:59], v[122:123], v[156:157], v[58:59] op_sel_hi:[1,0,1]
  v_pk_fma_f32 v[60:61], v[124:125], v[156:157], v[60:61] op_sel_hi:[1,0,1]
  v_pk_fma_f32 v[62:63], v[126:127], v[156:157], v[62:63] op_sel_hi:[1,0,1]
  v_cvt_pk_bf16_f32 v112, v48, v49
  v_cvt_pk_bf16_f32 v113, v50, v51
  v_cvt_pk_bf16_f32 v114, v52, v53
  v_cvt_pk_bf16_f32 v115, v54, v55
  v_cvt_pk_bf16_f32 v116, v56, v57
  v_cvt_pk_bf16_f32 v117, v58, v59
  v_cvt_pk_bf16_f32 v118, v60, v61
  v_cvt_pk_bf16_f32 v119, v62, v63
  s_add_u32 s44, s46, 395264
  buffer_store_dwordx4 v[112:115], v226, s[24:27], s44 offen sc1
  s_add_u32 s44, s46, 396288
  buffer_store_dwordx4 v[116:119], v226, s[24:27], s44 offen sc1
  v_pk_add_f32 v[238:239], v[238:239], v[48:49]
  v_pk_add_f32 v[238:239], v[238:239], v[50:51]
  v_pk_add_f32 v[238:239], v[238:239], v[52:53]
  v_pk_add_f32 v[238:239], v[238:239], v[54:55]
  v_pk_add_f32 v[238:239], v[238:239], v[56:57]
  v_pk_add_f32 v[238:239], v[238:239], v[58:59]
  v_pk_add_f32 v[238:239], v[238:239], v[60:61]
  v_pk_add_f32 v[238:239], v[238:239], v[62:63]
  v_accvgpr_read_b32 v96, a144
  v_accvgpr_read_b32 v97, a145
  v_accvgpr_read_b32 v98, a146
  v_accvgpr_read_b32 v99, a147
  v_accvgpr_read_b32 v100, a148
  v_accvgpr_read_b32 v101, a149
  v_accvgpr_read_b32 v102, a150
  v_accvgpr_read_b32 v103, a151
  v_accvgpr_read_b32 v104, a152
  v_accvgpr_read_b32 v105, a153
  v_accvgpr_read_b32 v106, a154
  v_accvgpr_read_b32 v107, a155
  v_accvgpr_read_b32 v108, a156
  v_accvgpr_read_b32 v109, a157
  v_accvgpr_read_b32 v110, a158
  v_accvgpr_read_b32 v111, a159
  s_waitcnt lgkmcnt(4)
  v_pk_mul_f32 v[64:65], v[64:65], v[162:163] op_sel_hi:[1,0]
  v_pk_mul_f32 v[66:67], v[66:67], v[162:163] op_sel_hi:[1,0]
  v_pk_mul_f32 v[68:69], v[68:69], v[162:163] op_sel_hi:[1,0]
  v_pk_mul_f32 v[70:71], v[70:71], v[162:163] op_sel_hi:[1,0]
  v_pk_mul_f32 v[72:73], v[72:73], v[162:163] op_sel_hi:[1,0]
  v_pk_mul_f32 v[74:75], v[74:75], v[162:163] op_sel_hi:[1,0]
  v_pk_mul_f32 v[76:77], v[76:77], v[162:163] op_sel_hi:[1,0]
  v_pk_mul_f32 v[78:79], v[78:79], v[162:163] op_sel_hi:[1,0]
  v_pk_fma_f32 v[64:65], v[96:97], v[160:161], v[64:65] op_sel_hi:[1,0,1]
  v_pk_fma_f32 v[66:67], v[98:99], v[160:161], v[66:67] op_sel_hi:[1,0,1]
  v_pk_fma_f32 v[68:69], v[100:101], v[160:161], v[68:69] op_sel_hi:[1,0,1]
  v_pk_fma_f32 v[70:71], v[102:103], v[160:161], v[70:71] op_sel_hi:[1,0,1]
  v_pk_fma_f32 v[72:73], v[104:105], v[160:161], v[72:73] op_sel_hi:[1,0,1]
  v_pk_fma_f32 v[74:75], v[106:107], v[160:161], v[74:75] op_sel_hi:[1,0,1]
  v_pk_fma_f32 v[76:77], v[108:109], v[160:161], v[76:77] op_sel_hi:[1,0,1]
  v_pk_fma_f32 v[78:79], v[110:111], v[160:161], v[78:79] op_sel_hi:[1,0,1]
  v_cvt_pk_bf16_f32 v96, v64, v65
  v_cvt_pk_bf16_f32 v97, v66, v67
  v_cvt_pk_bf16_f32 v98, v68, v69
  v_cvt_pk_bf16_f32 v99, v70, v71
  v_cvt_pk_bf16_f32 v100, v72, v73
  v_cvt_pk_bf16_f32 v101, v74, v75
  v_cvt_pk_bf16_f32 v102, v76, v77
  v_cvt_pk_bf16_f32 v103, v78, v79
  s_add_u32 s44, s46, 526336
  buffer_store_dwordx4 v[96:99], v226, s[24:27], s44 offen sc1
  s_add_u32 s44, s46, 527360
  buffer_store_dwordx4 v[100:103], v226, s[24:27], s44 offen sc1
  v_pk_add_f32 v[238:239], v[238:239], v[64:65]
  v_pk_add_f32 v[238:239], v[238:239], v[66:67]
  v_pk_add_f32 v[238:239], v[238:239], v[68:69]
  v_pk_add_f32 v[238:239], v[238:239], v[70:71]
  v_pk_add_f32 v[238:239], v[238:239], v[72:73]
  v_pk_add_f32 v[238:239], v[238:239], v[74:75]
  v_pk_add_f32 v[238:239], v[238:239], v[76:77]
  v_pk_add_f32 v[238:239], v[238:239], v[78:79]
  v_accvgpr_read_b32 v112, a176
  v_accvgpr_read_b32 v113, a177
  v_accvgpr_read_b32 v114, a178
  v_accvgpr_read_b32 v115, a179
  v_accvgpr_read_b32 v116, a180
  v_accvgpr_read_b32 v117, a181
  v_accvgpr_read_b32 v118, a182
  v_accvgpr_read_b32 v119, a183
  v_accvgpr_read_b32 v120, a184
  v_accvgpr_read_b32 v121, a185
  v_accvgpr_read_b32 v122, a186
  v_accvgpr_read_b32 v123, a187
  v_accvgpr_read_b32 v124, a188
  v_accvgpr_read_b32 v125, a189
  v_accvgpr_read_b32 v126, a190
  v_accvgpr_read_b32 v127, a191
  s_waitcnt lgkmcnt(0)
  v_pk_mul_f32 v[80:81], v[80:81], v[166:167] op_sel_hi:[1,0]
  v_pk_mul_f32 v[82:83], v[82:83], v[166:167] op_sel_hi:[1,0]
  v_pk_mul_f32 v[84:85], v[84:85], v[166:167] op_sel_hi:[1,0]
  v_pk_mul_f32 v[86:87], v[86:87], v[166:167] op_sel_hi:[1,0]
  v_pk_mul_f32 v[88:89], v[88:89], v[166:167] op_sel_hi:[1,0]
  v_pk_mul_f32 v[90:91], v[90:91], v[166:167] op_sel_hi:[1,0]
  v_pk_mul_f32 v[92:93], v[92:93], v[166:167] op_sel_hi:[1,0]
  v_pk_mul_f32 v[94:95], v[94:95], v[166:167] op_sel_hi:[1,0]
  v_pk_fma_f32 v[80:81], v[112:113], v[164:165], v[80:81] op_sel_hi:[1,0,1]
  v_pk_fma_f32 v[82:83], v[114:115], v[164:165], v[82:83] op_sel_hi:[1,0,1]
  v_pk_fma_f32 v[84:85], v[116:117], v[164:165], v[84:85] op_sel_hi:[1,0,1]
  v_pk_fma_f32 v[86:87], v[118:119], v[164:165], v[86:87] op_sel_hi:[1,0,1]
  v_pk_fma_f32 v[88:89], v[120:121], v[164:165], v[88:89] op_sel_hi:[1,0,1]
  v_pk_fma_f32 v[90:91], v[122:123], v[164:165], v[90:91] op_sel_hi:[1,0,1]
  v_pk_fma_f32 v[92:93], v[124:125], v[164:165], v[92:93] op_sel_hi:[1,0,1]
  v_pk_fma_f32 v[94:95], v[126:127], v[164:165], v[94:95] op_sel_hi:[1,0,1]
  v_cvt_pk_bf16_f32 v112, v80, v81
  v_cvt_pk_bf16_f32 v113, v82, v83
  v_cvt_pk_bf16_f32 v114, v84, v85
  v_cvt_pk_bf16_f32 v115, v86, v87
  v_cvt_pk_bf16_f32 v116, v88, v89
  v_cvt_pk_bf16_f32 v117, v90, v91
  v_cvt_pk_bf16_f32 v118, v92, v93
  v_cvt_pk_bf16_f32 v119, v94, v95
  s_add_u32 s44, s46, 657408
  buffer_store_dwordx4 v[112:115], v226, s[24:27], s44 offen sc1
  s_add_u32 s44, s46, 658432
  buffer_store_dwordx4 v[116:119], v226, s[24:27], s44 offen sc1
  v_pk_add_f32 v[238:239], v[238:239], v[80:81]
  v_pk_add_f32 v[238:239], v[238:239], v[82:83]
  v_pk_add_f32 v[238:239], v[238:239], v[84:85]
  v_pk_add_f32 v[238:239], v[238:239], v[86:87]
  v_pk_add_f32 v[238:239], v[238:239], v[88:89]
  v_pk_add_f32 v[238:239], v[238:239], v[90:91]
  v_pk_add_f32 v[238:239], v[238:239], v[92:93]
  v_pk_add_f32 v[238:239], v[238:239], v[94:95]
L_ep_done:
  v_add_f32 v238, v238, v239
  v_sub_f32 v238, v238, v238
  v_cmp_u_f32 vcc, v238, v238
  s_mov_b64 s[46:47], vcc
  v_mov_b32 v239, 0x53800000
  v_cmp_nle_f32 vcc, v234, v239
  s_or_b64 s[46:47], s[46:47], vcc
  s_cmp_lg_u64 s[46:47], 0
  s_cselect_b32 s44, 1, 0
  s_lshl_b32 s45, s3, 2
  s_add_u32 s45, s45, 163776
  v_mov_b32 v238, s44
  v_mov_b32 v239, s45
  ds_write_b32 v239, v238
  s_waitcnt lgkmcnt(0)
  s_barrier
  v_mov_b32 v239, 163776
  ds_read_b128 v[240:243], v239
  s_waitcnt lgkmcnt(0)
  v_or3_b32 v238, v240, v241, v242
  v_or_b32 v238, v238, v243
  s_nop 0
  v_readfirstlane_b32 s44, v238
  s_xor_b32 s45, s41, 1
  s_and_b32 s44, s44, s45
  s_cmp_lg_u32 s44, 0
  s_cbranch_scc1 L_fallback
  v_mbcnt_lo_u32_b32 v2, -1, 0
  v_mbcnt_hi_u32_b32 v2, -1, v2
  s_and_b32 s57, s2, 7
  s_lshl_b32 s44, s57, 5
  s_add_u32 s45, s44, s93
  s_lshl_b32 s45, s45, 8
  v_mov_b32 v22, s45
  s_lshl_b32 s44, s34, 13
  v_lshlrev_b32 v24, 8, v2
  v_add_u32 v24, s44, v24
  s_lshl_b32 s87, 1, s35
  v_mov_b32 v23, s87
  s_cmp_ge_u32 s93, 27
  s_cbranch_scc1 L_notile
  global_load_dword v20, v22, s[94:95] sc1
  s_mul_i32 s76, s93, 57
  s_lshr_b32 s76, s76, 9
  s_mul_i32 s44, s76, 9
  s_sub_u32 s77, s93, s44
  v_lshrrev_b32 v3, 4, v2
  v_and_b32 v4, 15, v2
  v_lshlrev_b32 v10, 4, v2
  v_lshrrev_b32 v7, 3, v2
  v_and_b32 v8, 7, v2
  v_lshrrev_b32 v9, 1, v7
  v_and_b32 v9, 3, v9
  v_lshlrev_b32 v9, 1, v9
  v_xor_b32 v8, v8, v9
  v_lshlrev_b32 v8, 4, v8
  v_mul_u32_u24 v7, 1152, v7
  v_add_u32 v11, v7, v8
  v_add_u32 v12, 8192, v11
  v_add_u32 v13, 16384, v11
  v_add_u32 v14, 24576, v11
  s_mul_i32 s44, s57, 12
  s_lshl_b32 s45, s76, 2
  s_add_u32 s44, s44, s45
  s_lshl_b32 s44, s44, 17
  s_lshl_b32 s45, s3, 15
  s_add_u32 s78, s44, s45
  s_mul_i32 s79, s3, 1179648
  s_lshl_b32 s80, s3, 15
  s_mov_b32 s85, 0
  s_mov_b32 s86, 300000
  s_lshl_b32 s44, s77, 7
  s_add_u32 s8, s58, s44
  s_addc_u32 s9, s59, 0
  s_and_b32 s9, s9, 0xffff
  s_sub_u32 s10, 4718592, s44
  s_mov_b32 s11, 0x20000
  s_mov_b32 s12, s32
  s_and_b32 s13, s33, 0xffff
  s_mov_b32 s14, 12582912
  s_mov_b32 s15, 0x20000
  s_mov_b32 s16, s88
  s_and_b32 s17, s89, 0xffff
  s_mov_b32 s18, 1769472
  s_mov_b32 s19, 0x20000
  s_add_u32 s46, s85, 0
  s_and_b32 s46, s46, 7
  s_mul_i32 s81, s46, 147456
  s_add_u32 s81, s81, s79
  s_add_u32 m0, s80, 0
  s_add_u32 s44, s81, 0
  buffer_load_dwordx4 v11, s[8:11], s44 offen offset:0 lds
  buffer_load_dwordx4 v12, s[8:11], s44 offen offset:1024 lds
  buffer_load_dwordx4 v13, s[8:11], s44 offen offset:2048 lds
  buffer_load_dwordx4 v14, s[8:11], s44 offen offset:3072 lds
  s_add_u32 m0, s80, 4096
  s_add_u32 s44, s81, 36864
  buffer_load_dwordx4 v11, s[8:11], s44 offen offset:0 lds
  buffer_load_dwordx4 v12, s[8:11], s44 offen offset:1024 lds
  buffer_load_dwordx4 v13, s[8:11], s44 offen offset:2048 lds
  buffer_load_dwordx4 v14, s[8:11], s44 offen offset:3072 lds
  s_add_u32 m0, s80, 8192
  s_add_u32 s44, s81, 73728
  buffer_load_dwordx4 v11, s[8:11], s44 offen offset:0 lds
  buffer_load_dwordx4 v12, s[8:11], s44 offen offset:1024 lds
  buffer_load_dwordx4 v13, s[8:11], s44 offen offset:2048 lds
  buffer_load_dwordx4 v14, s[8:11], s44 offen offset:3072 lds
  s_add_u32 m0, s80, 12288
  s_add_u32 s44, s81, 110592
  buffer_load_dwordx4 v11, s[8:11], s44 offen offset:0 lds
  buffer_load_dwordx4 v12, s[8:11], s44 offen offset:1024 lds
  buffer_load_dwordx4 v13, s[8:11], s44 offen offset:2048 lds
  buffer_load_dwordx4 v14, s[8:11], s44 offen offset:3072 lds
  s_add_u32 s46, s85, 1
  s_and_b32 s46, s46, 7
  s_mul_i32 s81, s46, 147456
  s_add_u32 s81, s81, s79
  s_add_u32 m0, s80, 16384
  s_add_u32 s44, s81, 0
  buffer_load_dwordx4 v11, s[8:11], s44 offen offset:0 lds
  buffer_load_dwordx4 v12, s[8:11], s44 offen offset:1024 lds
  buffer_load_dwordx4 v13, s[8:11], s44 offen offset:2048 lds
  buffer_load_dwordx4 v14, s[8:11], s44 offen offset:3072 lds
  s_add_u32 m0, s80, 20480
  s_add_u32 s44, s81, 36864
  buffer_load_dwordx4 v11, s[8:11], s44 offen offset:0 lds
  buffer_load_dwordx4 v12, s[8:11], s44 offen offset:1024 lds
  buffer_load_dwordx4 v13, s[8:11], s44 offen offset:2048 lds
  buffer_load_dwordx4 v14, s[8:11], s44 offen offset:3072 lds
  v_lshrrev_b32 v7, 2, v4
  v_and_b32 v8, 3, v4
  v_lshl_add_u32 v9, v3, 2, v7
  v_lshrrev_b32 v5, 1, v9
  v_and_b32 v5, 3, v5
  v_lshlrev_b32 v5, 1, v5
  v_lshrrev_b32 v6, 1, v8
  v_xor_b32 v5, v5, v6
  v_lshlrev_b32 v5, 4, v5
  v_and_b32 v6, 1, v8
  v_lshl_add_u32 v5, v6, 3, v5
  v_lshl_add_u32 v5, v9, 7, v5
  v_add_u32 v16, s80, v5
  v_xor_b32 v17, 32, v16
  v_xor_b32 v18, 64, v16
  v_xor_b32 v19, 96, v16
  s_waitcnt vmcnt(25)
  s_barrier
  s_cmp_eq_u32 s3, 0
  s_cbranch_scc0 L_nopub
  s_mov_b64 exec, 0x7ffffff
  global_atomic_add v24, v23, s[94:95]
  s_mov_b64 exec, -1
L_nopub:
  s_waitcnt vmcnt(24)
  v_readfirstlane_b32 s83, v20
  s_add_u32 s46, s85, 0
  s_and_b32 s46, s46, 7
  s_lshl_b32 s82, s46, 12
  s_lshl_b32 s84, s3, 3
  s_add_u32 s84, s84, s46
  s_add_u32 s82, s82, s78
  s_bitcmp1_b32 s83, s84
  s_cbranch_scc1 L_fok0
  L_fsp0:
  s_sleep 1
  global_load_dword v20, v22, s[94:95] sc1
  s_waitcnt vmcnt(0)
  v_readfirstlane_b32 s46, v20
  s_sub_u32 s86, s86, 1
  s_or_b32 s83, s83, s46
  s_cmp_eq_u32 s86, 0
  s_cbranch_scc1 L_fok0
  s_bitcmp1_b32 s83, s84
  s_cbranch_scc0 L_fsp0
  L_fok0:
  global_load_dword v20, v22, s[94:95] sc1
  s_add_u32 s45, s82, 0
  buffer_load_dwordx4 v[96:99], v10, s[12:15], s45 offen sc1
  s_add_u32 s45, s82, 131072
  buffer_load_dwordx4 v[100:103], v10, s[12:15], s45 offen sc1
  s_add_u32 s45, s82, 262144
  buffer_load_dwordx4 v[104:107], v10, s[12:15], s45 offen sc1
  s_add_u32 s45, s82, 393216
  buffer_load_dwordx4 v[108:111], v10, s[12:15], s45 offen sc1
  s_add_u32 s45, s82, 1024
  buffer_load_dwordx4 v[112:115], v10, s[12:15], s45 offen sc1
  s_add_u32 s45, s82, 132096
  buffer_load_dwordx4 v[116:119], v10, s[12:15], s45 offen sc1
  s_add_u32 s45, s82, 263168
  buffer_load_dwordx4 v[120:123], v10, s[12:15], s45 offen sc1
  s_add_u32 s45, s82, 394240
  buffer_load_dwordx4 v[124:127], v10, s[12:15], s45 offen sc1
  s_add_u32 s45, s82, 2048
  buffer_load_dwordx4 v[128:131], v10, s[12:15], s45 offen sc1
  s_add_u32 s45, s82, 133120
  buffer_load_dwordx4 v[132:135], v10, s[12:15], s45 offen sc1
  s_add_u32 s45, s82, 264192
  buffer_load_dwordx4 v[136:139], v10, s[12:15], s45 offen sc1
  s_add_u32 s45, s82, 395264
  buffer_load_dwordx4 v[140:143], v10, s[12:15], s45 offen sc1
  s_add_u32 s45, s82, 3072
  buffer_load_dwordx4 v[144:147], v10, s[12:15], s45 offen sc1
  s_add_u32 s45, s82, 134144
  buffer_load_dwordx4 v[148:151], v10, s[12:15], s45 offen sc1
  s_add_u32 s45, s82, 265216
  buffer_load_dwordx4 v[152:155], v10, s[12:15], s45 offen sc1
  s_add_u32 s45, s82, 396288
  buffer_load_dwordx4 v[156:159], v10, s[12:15], s45 offen sc1
  s_add_u32 s46, s85, 1
  s_and_b32 s46, s46, 7
  s_lshl_b32 s82, s46, 12
  s_lshl_b32 s84, s3, 3
  s_add_u32 s84, s84, s46
  s_add_u32 s82, s82, s78
  s_bitcmp1_b32 s83, s84
  s_cbranch_scc1 L_fok1
  L_fsp1:
  s_sleep 1
  global_load_dword v21, v22, s[94:95] sc1
  s_waitcnt vmcnt(0)
  v_readfirstlane_b32 s46, v21
  s_sub_u32 s86, s86, 1
  s_or_b32 s83, s83, s46
  s_cmp_eq_u32 s86, 0
  s_cbranch_scc1 L_fok1
  s_bitcmp1_b32 s83, s84
  s_cbranch_scc0 L_fsp1
  L_fok1:
  global_load_dword v21, v22, s[94:95] sc1
  s_add_u32 s45, s82, 0
  buffer_load_dwordx4 v[160:163], v10, s[12:15], s45 offen sc1
  s_add_u32 s45, s82, 131072
  buffer_load_dwordx4 v[164:167], v10, s[12:15], s45 offen sc1
  s_add_u32 s45, s82, 262144
  buffer_load_dwordx4 v[168:171], v10, s[12:15], s45 offen sc1
  s_add_u32 s45, s82, 393216
  buffer_load_dwordx4 v[172:175], v10, s[12:15], s45 offen sc1
  s_add_u32 s45, s82, 1024
  buffer_load_dwordx4 v[176:179], v10, s[12:15], s45 offen sc1
  s_add_u32 s45, s82, 132096
  buffer_load_dwordx4 v[180:183], v10, s[12:15], s45 offen sc1
  s_add_u32 s45, s82, 263168
  buffer_load_dwordx4 v[184:187], v10, s[12:15], s45 offen sc1
  s_add_u32 s45, s82, 394240
  buffer_load_dwordx4 v[188:191], v10, s[12:15], s45 offen sc1
  s_waitcnt vmcnt(20)
  ds_read_b64_tr_b16 v[208:209], v16 offset:0
  ds_read_b64_tr_b16 v[210:211], v16 offset:2048
  ds_read_b64_tr_b16 v[212:213], v17 offset:0
  ds_read_b64_tr_b16 v[214:215], v17 offset:2048
  ds_read_b64_tr_b16 v[216:217], v18 offset:0
  ds_read_b64_tr_b16 v[218:219], v18 offset:2048
  ds_read_b64_tr_b16 v[220:221], v19 offset:0
  ds_read_b64_tr_b16 v[222:223], v19 offset:2048
  s_waitcnt lgkmcnt(0)
  v_mfma_f32_16x16x32_bf16 v[32:35], v[208:211], v[96:99], 0
  s_add_u32 m0, s80, 24576
  s_add_u32 s44, s81, 73728
  buffer_load_dwordx4 v11, s[8:11], s44 offen offset:0 lds
  v_mfma_f32_16x16x32_bf16 v[36:39], v[208:211], v[100:103], 0
  buffer_load_dwordx4 v12, s[8:11], s44 offen offset:1024 lds
  v_mfma_f32_16x16x32_bf16 v[40:43], v[208:211], v[104:107], 0
  buffer_load_dwordx4 v13, s[8:11], s44 offen offset:2048 lds
  v_mfma_f32_16x16x32_bf16 v[44:47], v[208:211], v[108:111], 0
  buffer_load_dwordx4 v14, s[8:11], s44 offen offset:3072 lds
  v_mfma_f32_16x16x32_bf16 v[48:51], v[212:215], v[96:99], 0
  s_add_u32 s45, s82, 2048
  buffer_load_dwordx4 v[192:195], v10, s[12:15], s45 offen sc1
  v_mfma_f32_16x16x32_bf16 v[52:55], v[212:215], v[100:103], 0
  s_add_u32 s45, s82, 133120
  buffer_load_dwordx4 v[196:199], v10, s[12:15], s45 offen sc1
  v_mfma_f32_16x16x32_bf16 v[56:59], v[212:215], v[104:107], 0
  s_add_u32 s45, s82, 264192
  buffer_load_dwordx4 v[200:203], v10, s[12:15], s45 offen sc1
  v_mfma_f32_16x16x32_bf16 v[60:63], v[212:215], v[108:111], 0
  s_add_u32 s45, s82, 395264
  buffer_load_dwordx4 v[204:207], v10, s[12:15], s45 offen sc1
  s_waitcnt vmcnt(24)
  v_mfma_f32_16x16x32_bf16 v[64:67], v[216:219], v[96:99], 0
  ds_read_b64_tr_b16 v[224:225], v16 offset:4096
  v_mfma_f32_16x16x32_bf16 v[68:71], v[216:219], v[100:103], 0
  ds_read_b64_tr_b16 v[226:227], v16 offset:6144
  v_mfma_f32_16x16x32_bf16 v[72:75], v[216:219], v[104:107], 0
  ds_read_b64_tr_b16 v[228:229], v17 offset:4096
  v_mfma_f32_16x16x32_bf16 v[76:79], v[216:219], v[108:111], 0
  ds_read_b64_tr_b16 v[230:231], v17 offset:6144
  v_mfma_f32_16x16x32_bf16 v[80:83], v[220:223], v[96:99], 0
  ds_read_b64_tr_b16 v[232:233], v18 offset:4096
  v_mfma_f32_16x16x32_bf16 v[84:87], v[220:223], v[100:103], 0
  ds_read_b64_tr_b16 v[234:235], v18 offset:6144
  v_mfma_f32_16x16x32_bf16 v[88:91], v[220:223], v[104:107], 0
  ds_read_b64_tr_b16 v[236:237], v19 offset:4096
  v_mfma_f32_16x16x32_bf16 v[92:95], v[220:223], v[108:111], 0
  ds_read_b64_tr_b16 v[238:239], v19 offset:6144
  s_waitcnt lgkmcnt(0)
  v_mfma_f32_16x16x32_bf16 v[32:35], v[224:227], v[112:115], v[32:35]
  s_add_u32 m0, s80, 28672
  s_add_u32 s44, s81, 110592
  buffer_load_dwordx4 v11, s[8:11], s44 offen offset:0 lds
  v_mfma_f32_16x16x32_bf16 v[36:39], v[224:227], v[116:119], v[36:39]
  buffer_load_dwordx4 v12, s[8:11], s44 offen offset:1024 lds
  v_mfma_f32_16x16x32_bf16 v[40:43], v[224:227], v[120:123], v[40:43]
  buffer_load_dwordx4 v13, s[8:11], s44 offen offset:2048 lds
  v_mfma_f32_16x16x32_bf16 v[44:47], v[224:227], v[124:127], v[44:47]
  buffer_load_dwordx4 v14, s[8:11], s44 offen offset:3072 lds
  v_mfma_f32_16x16x32_bf16 v[48:51], v[228:231], v[112:115], v[48:51]
  s_add_u32 s45, s82, 3072
  buffer_load_dwordx4 v[96:99], v10, s[12:15], s45 offen sc1
  v_mfma_f32_16x16x32_bf16 v[52:55], v[228:231], v[116:119], v[52:55]
  s_add_u32 s45, s82, 134144
  buffer_load_dwordx4 v[100:103], v10, s[12:15], s45 offen sc1
  v_mfma_f32_16x16x32_bf16 v[56:59], v[228:231], v[120:123], v[56:59]
  s_add_u32 s45, s82, 265216
  buffer_load_dwordx4 v[104:107], v10, s[12:15], s45 offen sc1
  v_mfma_f32_16x16x32_bf16 v[60:63], v[228:231], v[124:127], v[60:63]
  s_add_u32 s45, s82, 396288
  buffer_load_dwordx4 v[108:111], v10, s[12:15], s45 offen sc1
  s_waitcnt vmcnt(28)
  v_mfma_f32_16x16x32_bf16 v[64:67], v[232:235], v[112:115], v[64:67]
  ds_read_b64_tr_b16 v[208:209], v16 offset:8192
  v_mfma_f32_16x16x32_bf16 v[68:71], v[232:235], v[116:119], v[68:71]
  ds_read_b64_tr_b16 v[210:211], v16 offset:10240
  v_mfma_f32_16x16x32_bf16 v[72:75], v[232:235], v[120:123], v[72:75]
  ds_read_b64_tr_b16 v[212:213], v17 offset:8192
  v_mfma_f32_16x16x32_bf16 v[76:79], v[232:235], v[124:127], v[76:79]
  ds_read_b64_tr_b16 v[214:215], v17 offset:10240
  v_mfma_f32_16x16x32_bf16 v[80:83], v[236:239], v[112:115], v[80:83]
  ds_read_b64_tr_b16 v[216:217], v18 offset:8192
  v_mfma_f32_16x16x32_bf16 v[84:87], v[236:239], v[116:119], v[84:87]
  ds_read_b64_tr_b16 v[218:219], v18 offset:10240
  v_mfma_f32_16x16x32_bf16 v[88:91], v[236:239], v[120:123], v[88:91]
  ds_read_b64_tr_b16 v[220:221], v19 offset:8192
  v_mfma_f32_16x16x32_bf16 v[92:95], v[236:239], v[124:127], v[92:95]
  ds_read_b64_tr_b16 v[222:223], v19 offset:10240
  s_waitcnt lgkmcnt(0)
  v_mfma_f32_16x16x32_bf16 v[32:35], v[208:211], v[128:131], v[32:35]
  s_add_u32 s46, s85, 2
  s_and_b32 s46, s46, 7
  s_mul_i32 s81, s46, 147456
  s_add_u32 s81, s81, s79
  s_add_u32 m0, s80, 0
  s_add_u32 s44, s81, 0
  buffer_load_dwordx4 v11, s[8:11], s44 offen offset:0 lds
  buffer_load_dwordx4 v12, s[8:11], s44 offen offset:1024 lds
  v_mfma_f32_16x16x32_bf16 v[36:39], v[208:211], v[132:135], v[36:39]
  buffer_load_dwordx4 v13, s[8:11], s44 offen offset:2048 lds
  v_mfma_f32_16x16x32_bf16 v[40:43], v[208:211], v[136:139], v[40:43]
  buffer_load_dwordx4 v14, s[8:11], s44 offen offset:3072 lds
  v_mfma_f32_16x16x32_bf16 v[44:47], v[208:211], v[140:143], v[44:47]
  s_add_u32 s46, s85, 2
  s_and_b32 s46, s46, 7
  s_lshl_b32 s82, s46, 12
  s_lshl_b32 s84, s3, 3
  s_add_u32 s84, s84, s46
  s_add_u32 s82, s82, s78
  v_readfirstlane_b32 s46, v20
  s_nop 0
  s_or_b32 s83, s83, s46
  s_bitcmp1_b32 s83, s84
  s_cbranch_scc1 L_fok2
  L_fsp2:
  s_sleep 1
  global_load_dword v20, v22, s[94:95] sc1
  s_waitcnt vmcnt(0)
  v_readfirstlane_b32 s46, v20
  s_sub_u32 s86, s86, 1
  s_or_b32 s83, s83, s46
  s_cmp_eq_u32 s86, 0
  s_cbranch_scc1 L_fok2
  s_bitcmp1_b32 s83, s84
  s_cbranch_scc0 L_fsp2
  L_fok2:
  global_load_dword v20, v22, s[94:95] sc1
  v_mfma_f32_16x16x32_bf16 v[48:51], v[212:215], v[128:131], v[48:51]
  s_add_u32 s45, s82, 0
  buffer_load_dwordx4 v[112:115], v10, s[12:15], s45 offen sc1
  v_mfma_f32_16x16x32_bf16 v[52:55], v[212:215], v[132:135], v[52:55]
  s_add_u32 s45, s82, 131072
  buffer_load_dwordx4 v[116:119], v10, s[12:15], s45 offen sc1
  v_mfma_f32_16x16x32_bf16 v[56:59], v[212:215], v[136:139], v[56:59]
  s_add_u32 s45, s82, 262144
  buffer_load_dwordx4 v[120:123], v10, s[12:15], s45 offen sc1
  v_mfma_f32_16x16x32_bf16 v[60:63], v[212:215], v[140:143], v[60:63]
  s_add_u32 s45, s82, 393216
  buffer_load_dwordx4 v[124:127], v10, s[12:15], s45 offen sc1
  s_waitcnt vmcnt(32)
  v_mfma_f32_16x16x32_bf16 v[64:67], v[216:219], v[128:131], v[64:67]
  ds_read_b64_tr_b16 v[224:225], v16 offset:12288
  v_mfma_f32_16x16x32_bf16 v[68:71], v[216:219], v[132:135], v[68:71]
  ds_read_b64_tr_b16 v[226:227], v16 offset:14336
  v_mfma_f32_16x16x32_bf16 v[72:75], v[216:219], v[136:139], v[72:75]
  ds_read_b64_tr_b16 v[228:229], v17 offset:12288
  v_mfma_f32_16x16x32_bf16 v[76:79], v[216:219], v[140:143], v[76:79]
  ds_read_b64_tr_b16 v[230:231], v17 offset:14336
  v_mfma_f32_16x16x32_bf16 v[80:83], v[220:223], v[128:131], v[80:83]
  ds_read_b64_tr_b16 v[232:233], v18 offset:12288
  v_mfma_f32_16x16x32_bf16 v[84:87], v[220:223], v[132:135], v[84:87]
  ds_read_b64_tr_b16 v[234:235], v18 offset:14336
  v_mfma_f32_16x16x32_bf16 v[88:91], v[220:223], v[136:139], v[88:91]
  ds_read_b64_tr_b16 v[236:237], v19 offset:12288
  v_mfma_f32_16x16x32_bf16 v[92:95], v[220:223], v[140:143], v[92:95]
  ds_read_b64_tr_b16 v[238:239], v19 offset:14336
  s_waitcnt lgkmcnt(0)
  v_mfma_f32_16x16x32_bf16 v[32:35], v[224:227], v[144:147], v[32:35]
  s_add_u32 m0, s80, 4096
  s_add_u32 s44, s81, 36864
  buffer_load_dwordx4 v11, s[8:11], s44 offen offset:0 lds
  v_mfma_f32_16x16x32_bf16 v[36:39], v[224:227], v[148:151], v[36:39]
  buffer_load_dwordx4 v12, s[8:11], s44 offen offset:1024 lds
  v_mfma_f32_16x16x32_bf16 v[40:43], v[224:227], v[152:155], v[40:43]
  buffer_load_dwordx4 v13, s[8:11], s44 offen offset:2048 lds
  v_mfma_f32_16x16x32_bf16 v[44:47], v[224:227], v[156:159], v[44:47]
  buffer_load_dwordx4 v14, s[8:11], s44 offen offset:3072 lds
  v_mfma_f32_16x16x32_bf16 v[48:51], v[228:231], v[144:147], v[48:51]
  s_add_u32 s45, s82, 1024
  buffer_load_dwordx4 v[128:131], v10, s[12:15], s45 offen sc1
  v_mfma_f32_16x16x32_bf16 v[52:55], v[228:231], v[148:151], v[52:55]
  s_add_u32 s45, s82, 132096
  buffer_load_dwordx4 v[132:135], v10, s[12:15], s45 offen sc1
  v_mfma_f32_16x16x32_bf16 v[56:59], v[228:231], v[152:155], v[56:59]
  s_add_u32 s45, s82, 263168
  buffer_load_dwordx4 v[136:139], v10, s[12:15], s45 offen sc1
  v_mfma_f32_16x16x32_bf16 v[60:63], v[228:231], v[156:159], v[60:63]
  s_add_u32 s45, s82, 394240
  buffer_load_dwordx4 v[140:143], v10, s[12:15], s45 offen sc1
  s_waitcnt vmcnt(36)
  v_mfma_f32_16x16x32_bf16 v[64:67], v[232:235], v[144:147], v[64:67]
  ds_read_b64_tr_b16 v[208:209], v16 offset:16384
  v_mfma_f32_16x16x32_bf16 v[68:71], v[232:235], v[148:151], v[68:71]
  ds_read_b64_tr_b16 v[210:211], v16 offset:18432
  v_mfma_f32_16x16x32_bf16 v[72:75], v[232:235], v[152:155], v[72:75]
  ds_read_b64_tr_b16 v[212:213], v17 offset:16384
  v_mfma_f32_16x16x32_bf16 v[76:79], v[232:235], v[156:159], v[76:79]
  ds_read_b64_tr_b16 v[214:215], v17 offset:18432
  v_mfma_f32_16x16x32_bf16 v[80:83], v[236:239], v[144:147], v[80:83]
  ds_read_b64_tr_b16 v[216:217], v18 offset:16384
  v_mfma_f32_16x16x32_bf16 v[84:87], v[236:239], v[148:151], v[84:87]
  ds_read_b64_tr_b16 v[218:219], v18 offset:18432
  v_mfma_f32_16x16x32_bf16 v[88:91], v[236:239], v[152:155], v[88:91]
  ds_read_b64_tr_b16 v[220:221], v19 offset:16384
  v_mfma_f32_16x16x32_bf16 v[92:95], v[236:239], v[156:159], v[92:95]
  ds_read_b64_tr_b16 v[222:223], v19 offset:18432
  s_waitcnt lgkmcnt(0)
  v_mfma_f32_16x16x32_bf16 v[32:35], v[208:211], v[160:163], v[32:35]
  s_add_u32 m0, s80, 8192
  s_add_u32 s44, s81, 73728
  buffer_load_dwordx4 v11, s[8:11], s44 offen offset:0 lds
  v_mfma_f32_16x16x32_bf16 v[36:39], v[208:211], v[164:167], v[36:39]
  buffer_load_dwordx4 v12, s[8:11], s44 offen offset:1024 lds
  v_mfma_f32_16x16x32_bf16 v[40:43], v[208:211], v[168:171], v[40:43]
  buffer_load_dwordx4 v13, s[8:11], s44 offen offset:2048 lds
  v_mfma_f32_16x16x32_bf16 v[44:47], v[208:211], v[172:175], v[44:47]
  buffer_load_dwordx4 v14, s[8:11], s44 offen offset:3072 lds
  v_mfma_f32_16x16x32_bf16 v[48:51], v[212:215], v[160:163], v[48:51]
  s_add_u32 s45, s82, 2048
  buffer_load_dwordx4 v[144:147], v10, s[12:15], s45 offen sc1
  v_mfma_f32_16x16x32_bf16 v[52:55], v[212:215], v[164:167], v[52:55]
  s_add_u32 s45, s82, 133120
  buffer_load_dwordx4 v[148:151], v10, s[12:15], s45 offen sc1
  v_mfma_f32_16x16x32_bf16 v[56:59], v[212:215], v[168:171], v[56:59]
  s_add_u32 s45, s82, 264192
  buffer_load_dwordx4 v[152:155], v10, s[12:15], s45 offen sc1
  v_mfma_f32_16x16x32_bf16 v[60:63], v[212:215], v[172:175], v[60:63]
  s_add_u32 s45, s82, 395264
  buffer_load_dwordx4 v[156:159], v10, s[12:15], s45 offen sc1
  s_waitcnt vmcnt(40)
  v_mfma_f32_16x16x32_bf16 v[64:67], v[216:219], v[160:163], v[64:67]
  ds_read_b64_tr_b16 v[224:225], v16 offset:20480
  v_mfma_f32_16x16x32_bf16 v[68:71], v[216:219], v[164:167], v[68:71]
  ds_read_b64_tr_b16 v[226:227], v16 offset:22528
  v_mfma_f32_16x16x32_bf16 v[72:75], v[216:219], v[168:171], v[72:75]
  ds_read_b64_tr_b16 v[228:229], v17 offset:20480
  v_mfma_f32_16x16x32_bf16 v[76:79], v[216:219], v[172:175], v[76:79]
  ds_read_b64_tr_b16 v[230:231], v17 offset:22528
  v_mfma_f32_16x16x32_bf16 v[80:83], v[220:223], v[160:163], v[80:83]
  ds_read_b64_tr_b16 v[232:233], v18 offset:20480
  v_mfma_f32_16x16x32_bf16 v[84:87], v[220:223], v[164:167], v[84:87]
  ds_read_b64_tr_b16 v[234:235], v18 offset:22528
  v_mfma_f32_16x16x32_bf16 v[88:91], v[220:223], v[168:171], v[88:91]
  ds_read_b64_tr_b16 v[236:237], v19 offset:20480
  v_mfma_f32_16x16x32_bf16 v[92:95], v[220:223], v[172:175], v[92:95]
  ds_read_b64_tr_b16 v[238:239], v19 offset:22528
  s_waitcnt lgkmcnt(0)
  v_mfma_f32_16x16x32_bf16 v[32:35], v[224:227], v[176:179], v[32:35]
  s_add_u32 m0, s80, 12288
  s_add_u32 s44, s81, 110592
  buffer_load_dwordx4 v11, s[8:11], s44 offen offset:0 lds
  v_mfma_f32_16x16x32_bf16 v[36:39], v[224:227], v[180:183], v[36:39]
  buffer_load_dwordx4 v12, s[8:11], s44 offen offset:1024 lds
  v_mfma_f32_16x16x32_bf16 v[40:43], v[224:227], v[184:187], v[40:43]
  buffer_load_dwordx4 v13, s[8:11], s44 offen offset:2048 lds
  v_mfma_f32_16x16x32_bf16 v[44:47], v[224:227], v[188:191], v[44:47]
  buffer_load_dwordx4 v14, s[8:11], s44 offen offset:3072 lds
  v_mfma_f32_16x16x32_bf16 v[48:51], v[228:231], v[176:179], v[48:51]
  s_add_u32 s45, s82, 3072
  buffer_load_dwordx4 v[160:163], v10, s[12:15], s45 offen sc1
  v_mfma_f32_16x16x32_bf16 v[52:55], v[228:231], v[180:183], v[52:55]
  s_add_u32 s45, s82, 134144
  buffer_load_dwordx4 v[164:167], v10, s[12:15], s45 offen sc1
  v_mfma_f32_16x16x32_bf16 v[56:59], v[228:231], v[184:187], v[56:59]
  s_add_u32 s45, s82, 265216
  buffer_load_dwordx4 v[168:171], v10, s[12:15], s45 offen sc1
  v_mfma_f32_16x16x32_bf16 v[60:63], v[228:231], v[188:191], v[60:63]
  s_add_u32 s45, s82, 396288
  buffer_load_dwordx4 v[172:175], v10, s[12:15], s45 offen sc1
  s_waitcnt vmcnt(40)
  v_mfma_f32_16x16x32_bf16 v[64:67], v[232:235], v[176:179], v[64:67]
  ds_read_b64_tr_b16 v[208:209], v16 offset:24576
  v_mfma_f32_16x16x32_bf16 v[68:71], v[232:235], v[180:183], v[68:71]
  ds_read_b64_tr_b16 v[210:211], v16 offset:26624
  v_mfma_f32_16x16x32_bf16 v[72:75], v[232:235], v[184:187], v[72:75]
  ds_read_b64_tr_b16 v[212:213], v17 offset:24576
  v_mfma_f32_16x16x32_bf16 v[76:79], v[232:235], v[188:191], v[76:79]
  ds_read_b64_tr_b16 v[214:215], v17 offset:26624
  v_mfma_f32_16x16x32_bf16 v[80:83], v[236:239], v[176:179], v[80:83]
  ds_read_b64_tr_b16 v[216:217], v18 offset:24576
  v_mfma_f32_16x16x32_bf16 v[84:87], v[236:239], v[180:183], v[84:87]
  ds_read_b64_tr_b16 v[218:219], v18 offset:26624
  v_mfma_f32_16x16x32_bf16 v[88:91], v[236:239], v[184:187], v[88:91]
  ds_read_b64_tr_b16 v[220:221], v19 offset:24576
  v_mfma_f32_16x16x32_bf16 v[92:95], v[236:239], v[188:191], v[92:95]
  ds_read_b64_tr_b16 v[222:223], v19 offset:26624
  s_waitcnt lgkmcnt(0)
  v_mfma_f32_16x16x32_bf16 v[32:35], v[208:211], v[192:195], v[32:35]
  s_add_u32 s46, s85, 3
  s_and_b32 s46, s46, 7
  s_mul_i32 s81, s46, 147456
  s_add_u32 s81, s81, s79
  s_add_u32 m0, s80, 16384
  s_add_u32 s44, s81, 0
  buffer_load_dwordx4 v11, s[8:11], s44 offen offset:0 lds
  buffer_load_dwordx4 v12, s[8:11], s44 offen offset:1024 lds
  v_mfma_f32_16x16x32_bf16 v[36:39], v[208:211], v[196:199], v[36:39]
  buffer_load_dwordx4 v13, s[8:11], s44 offen offset:2048 lds
  v_mfma_f32_16x16x32_bf16 v[40:43], v[208:211], v[200:203], v[40:43]
  buffer_load_dwordx4 v14, s[8:11], s44 offen offset:3072 lds
  v_mfma_f32_16x16x32_bf16 v[44:47], v[208:211], v[204:207], v[44:47]
  s_add_u32 s46, s85, 3
  s_and_b32 s46, s46, 7
  s_lshl_b32 s82, s46, 12
  s_lshl_b32 s84, s3, 3
  s_add_u32 s84, s84, s46
  s_add_u32 s82, s82, s78
  v_readfirstlane_b32 s46, v21
  s_nop 0
  s_or_b32 s83, s83, s46
  s_bitcmp1_b32 s83, s84
  s_cbranch_scc1 L_fok3
  L_fsp3:
  s_sleep 1
  global_load_dword v21, v22, s[94:95] sc1
  s_waitcnt vmcnt(0)
  v_readfirstlane_b32 s46, v21
  s_sub_u32 s86, s86, 1
  s_or_b32 s83, s83, s46
  s_cmp_eq_u32 s86, 0
  s_cbranch_scc1 L_fok3
  s_bitcmp1_b32 s83, s84
  s_cbranch_scc0 L_fsp3
  L_fok3:
  global_load_dword v21, v22, s[94:95] sc1
  v_mfma_f32_16x16x32_bf16 v[48:51], v[212:215], v[192:195], v[48:51]
  s_add_u32 s45, s82, 0
  buffer_load_dwordx4 v[176:179], v10, s[12:15], s45 offen sc1
  v_mfma_f32_16x16x32_bf16 v[52:55], v[212:215], v[196:199], v[52:55]
  s_add_u32 s45, s82, 131072
  buffer_load_dwordx4 v[180:183], v10, s[12:15], s45 offen sc1
  v_mfma_f32_16x16x32_bf16 v[56:59], v[212:215], v[200:203], v[56:59]
  s_add_u32 s45, s82, 262144
  buffer_load_dwordx4 v[184:187], v10, s[12:15], s45 offen sc1
  v_mfma_f32_16x16x32_bf16 v[60:63], v[212:215], v[204:207], v[60:63]
  s_add_u32 s45, s82, 393216
  buffer_load_dwordx4 v[188:191], v10, s[12:15], s45 offen sc1
  s_waitcnt vmcnt(40)
  v_mfma_f32_16x16x32_bf16 v[64:67], v[216:219], v[192:195], v[64:67]
  ds_read_b64_tr_b16 v[224:225], v16 offset:28672
  v_mfma_f32_16x16x32_bf16 v[68:71], v[216:219], v[196:199], v[68:71]
  ds_read_b64_tr_b16 v[226:227], v16 offset:30720
  v_mfma_f32_16x16x32_bf16 v[72:75], v[216:219], v[200:203], v[72:75]
  ds_read_b64_tr_b16 v[228:229], v17 offset:28672
  v_mfma_f32_16x16x32_bf16 v[76:79], v[216:219], v[204:207], v[76:79]
  ds_read_b64_tr_b16 v[230:231], v17 offset:30720
  v_mfma_f32_16x16x32_bf16 v[80:83], v[220:223], v[192:195], v[80:83]
  ds_read_b64_tr_b16 v[232:233], v18 offset:28672
  v_mfma_f32_16x16x32_bf16 v[84:87], v[220:223], v[196:199], v[84:87]
  ds_read_b64_tr_b16 v[234:235], v18 offset:30720
  v_mfma_f32_16x16x32_bf16 v[88:91], v[220:223], v[200:203], v[88:91]
  ds_read_b64_tr_b16 v[236:237], v19 offset:28672
  v_mfma_f32_16x16x32_bf16 v[92:95], v[220:223], v[204:207], v[92:95]
  ds_read_b64_tr_b16 v[238:239], v19 offset:30720
  s_waitcnt lgkmcnt(0)
  v_mfma_f32_16x16x32_bf16 v[32:35], v[224:227], v[96:99], v[32:35]
  s_add_u32 m0, s80, 20480
  s_add_u32 s44, s81, 36864
  buffer_load_dwordx4 v11, s[8:11], s44 offen offset:0 lds
  v_mfma_f32_16x16x32_bf16 v[36:39], v[224:227], v[100:103], v[36:39]
  buffer_load_dwordx4 v12, s[8:11], s44 offen offset:1024 lds
  v_mfma_f32_16x16x32_bf16 v[40:43], v[224:227], v[104:107], v[40:43]
  buffer_load_dwordx4 v13, s[8:11], s44 offen offset:2048 lds
  v_mfma_f32_16x16x32_bf16 v[44:47], v[224:227], v[108:111], v[44:47]
  buffer_load_dwordx4 v14, s[8:11], s44 offen offset:3072 lds
  v_mfma_f32_16x16x32_bf16 v[48:51], v[228:231], v[96:99], v[48:51]
  s_add_u32 s45, s82, 1024
  buffer_load_dwordx4 v[192:195], v10, s[12:15], s45 offen sc1
  v_mfma_f32_16x16x32_bf16 v[52:55], v[228:231], v[100:103], v[52:55]
  s_add_u32 s45, s82, 132096
  buffer_load_dwordx4 v[196:199], v10, s[12:15], s45 offen sc1
  v_mfma_f32_16x16x32_bf16 v[56:59], v[228:231], v[104:107], v[56:59]
  s_add_u32 s45, s82, 263168
  buffer_load_dwordx4 v[200:203], v10, s[12:15], s45 offen sc1
  v_mfma_f32_16x16x32_bf16 v[60:63], v[228:231], v[108:111], v[60:63]
  s_add_u32 s45, s82, 394240
  buffer_load_dwordx4 v[204:207], v10, s[12:15], s45 offen sc1
  s_waitcnt vmcnt(40)
  v_mfma_f32_16x16x32_bf16 v[64:67], v[232:235], v[96:99], v[64:67]
  ds_read_b64_tr_b16 v[208:209], v16 offset:0
  v_mfma_f32_16x16x32_bf16 v[68:71], v[232:235], v[100:103], v[68:71]
  ds_read_b64_tr_b16 v[210:211], v16 offset:2048
  v_mfma_f32_16x16x32_bf16 v[72:75], v[232:235], v[104:107], v[72:75]
  ds_read_b64_tr_b16 v[212:213], v17 offset:0
  v_mfma_f32_16x16x32_bf16 v[76:79], v[232:235], v[108:111], v[76:79]
  ds_read_b64_tr_b16 v[214:215], v17 offset:2048
  v_mfma_f32_16x16x32_bf16 v[80:83], v[236:239], v[96:99], v[80:83]
  ds_read_b64_tr_b16 v[216:217], v18 offset:0
  v_mfma_f32_16x16x32_bf16 v[84:87], v[236:239], v[100:103], v[84:87]
  ds_read_b64_tr_b16 v[218:219], v18 offset:2048
  v_mfma_f32_16x16x32_bf16 v[88:91], v[236:239], v[104:107], v[88:91]
  ds_read_b64_tr_b16 v[220:221], v19 offset:0
  v_mfma_f32_16x16x32_bf16 v[92:95], v[236:239], v[108:111], v[92:95]
  ds_read_b64_tr_b16 v[222:223], v19 offset:2048
  s_waitcnt lgkmcnt(0)
  v_mfma_f32_16x16x32_bf16 v[32:35], v[208:211], v[112:115], v[32:35]
  s_add_u32 m0, s80, 24576
  s_add_u32 s44, s81, 73728
  buffer_load_dwordx4 v11, s[8:11], s44 offen offset:0 lds
  v_mfma_f32_16x16x32_bf16 v[36:39], v[208:211], v[116:119], v[36:39]
  buffer_load_dwordx4 v12, s[8:11], s44 offen offset:1024 lds
  v_mfma_f32_16x16x32_bf16 v[40:43], v[208:211], v[120:123], v[40:43]
  buffer_load_dwordx4 v13, s[8:11], s44 offen offset:2048 lds
  v_mfma_f32_16x16x32_bf16 v[44:47], v[208:211], v[124:127], v[44:47]
  buffer_load_dwordx4 v14, s[8:11], s44 offen offset:3072 lds
  v_mfma_f32_16x16x32_bf16 v[48:51], v[212:215], v[112:115], v[48:51]
  s_add_u32 s45, s82, 2048
  buffer_load_dwordx4 v[96:99], v10, s[12:15], s45 offen sc1
  v_mfma_f32_16x16x32_bf16 v[52:55], v[212:215], v[116:119], v[52:55]
  s_add_u32 s45, s82, 133120
  buffer_load_dwordx4 v[100:103], v10, s[12:15], s45 offen sc1
  v_mfma_f32_16x16x32_bf16 v[56:59], v[212:215], v[120:123], v[56:59]
  s_add_u32 s45, s82, 264192
  buffer_load_dwordx4 v[104:107], v10, s[12:15], s45 offen sc1
  v_mfma_f32_16x16x32_bf16 v[60:63], v[212:215], v[124:127], v[60:63]
  s_add_u32 s45, s82, 395264
  buffer_load_dwordx4 v[108:111], v10, s[12:15], s45 offen sc1
  s_waitcnt vmcnt(40)
  v_mfma_f32_16x16x32_bf16 v[64:67], v[216:219], v[112:115], v[64:67]
  ds_read_b64_tr_b16 v[224:225], v16 offset:4096
  v_mfma_f32_16x16x32_bf16 v[68:71], v[216:219], v[116:119], v[68:71]
  ds_read_b64_tr_b16 v[226:227], v16 offset:6144
  v_mfma_f32_16x16x32_bf16 v[72:75], v[216:219], v[120:123], v[72:75]
  ds_read_b64_tr_b16 v[228:229], v17 offset:4096
  v_mfma_f32_16x16x32_bf16 v[76:79], v[216:219], v[124:127], v[76:79]
  ds_read_b64_tr_b16 v[230:231], v17 offset:6144
  v_mfma_f32_16x16x32_bf16 v[80:83], v[220:223], v[112:115], v[80:83]
  ds_read_b64_tr_b16 v[232:233], v18 offset:4096
  v_mfma_f32_16x16x32_bf16 v[84:87], v[220:223], v[116:119], v[84:87]
  ds_read_b64_tr_b16 v[234:235], v18 offset:6144
  v_mfma_f32_16x16x32_bf16 v[88:91], v[220:223], v[120:123], v[88:91]
  ds_read_b64_tr_b16 v[236:237], v19 offset:4096
  v_mfma_f32_16x16x32_bf16 v[92:95], v[220:223], v[124:127], v[92:95]
  ds_read_b64_tr_b16 v[238:239], v19 offset:6144
  s_waitcnt lgkmcnt(0)
  v_mfma_f32_16x16x32_bf16 v[32:35], v[224:227], v[128:131], v[32:35]
  s_add_u32 m0, s80, 28672
  s_add_u32 s44, s81, 110592
  buffer_load_dwordx4 v11, s[8:11], s44 offen offset:0 lds
  v_mfma_f32_16x16x32_bf16 v[36:39], v[224:227], v[132:135], v[36:39]
  buffer_load_dwordx4 v12, s[8:11], s44 offen offset:1024 lds
  v_mfma_f32_16x16x32_bf16 v[40:43], v[224:227], v[136:139], v[40:43]
  buffer_load_dwordx4 v13, s[8:11], s44 offen offset:2048 lds
  v_mfma_f32_16x16x32_bf16 v[44:47], v[224:227], v[140:143], v[44:47]
  buffer_load_dwordx4 v14, s[8:11], s44 offen offset:3072 lds
  v_mfma_f32_16x16x32_bf16 v[48:51], v[228:231], v[128:131], v[48:51]
  s_add_u32 s45, s82, 3072
  buffer_load_dwordx4 v[112:115], v10, s[12:15], s45 offen sc1
  v_mfma_f32_16x16x32_bf16 v[52:55], v[228:231], v[132:135], v[52:55]
  s_add_u32 s45, s82, 134144
  buffer_load_dwordx4 v[116:119], v10, s[12:15], s45 offen sc1
  v_mfma_f32_16x16x32_bf16 v[56:59], v[228:231], v[136:139], v[56:59]
  s_add_u32 s45, s82, 265216
  buffer_load_dwordx4 v[120:123], v10, s[12:15], s45 offen sc1
  v_mfma_f32_16x16x32_bf16 v[60:63], v[228:231], v[140:143], v[60:63]
  s_add_u32 s45, s82, 396288
  buffer_load_dwordx4 v[124:127], v10, s[12:15], s45 offen sc1
  s_waitcnt vmcnt(40)
  v_mfma_f32_16x16x32_bf16 v[64:67], v[232:235], v[128:131], v[64:67]
  ds_read_b64_tr_b16 v[208:209], v16 offset:8192
  v_mfma_f32_16x16x32_bf16 v[68:71], v[232:235], v[132:135], v[68:71]
  ds_read_b64_tr_b16 v[210:211], v16 offset:10240
  v_mfma_f32_16x16x32_bf16 v[72:75], v[232:235], v[136:139], v[72:75]
  ds_read_b64_tr_b16 v[212:213], v17 offset:8192
  v_mfma_f32_16x16x32_bf16 v[76:79], v[232:235], v[140:143], v[76:79]
  ds_read_b64_tr_b16 v[214:215], v17 offset:10240
  v_mfma_f32_16x16x32_bf16 v[80:83], v[236:239], v[128:131], v[80:83]
  ds_read_b64_tr_b16 v[216:217], v18 offset:8192
  v_mfma_f32_16x16x32_bf16 v[84:87], v[236:239], v[132:135], v[84:87]
  ds_read_b64_tr_b16 v[218:219], v18 offset:10240
  v_mfma_f32_16x16x32_bf16 v[88:91], v[236:239], v[136:139], v[88:91]
  ds_read_b64_tr_b16 v[220:221], v19 offset:8192
  v_mfma_f32_16x16x32_bf16 v[92:95], v[236:239], v[140:143], v[92:95]
  ds_read_b64_tr_b16 v[222:223], v19 offset:10240
  s_waitcnt lgkmcnt(0)
  v_mfma_f32_16x16x32_bf16 v[32:35], v[208:211], v[144:147], v[32:35]
  s_add_u32 s46, s85, 4
  s_and_b32 s46, s46, 7
  s_mul_i32 s81, s46, 147456
  s_add_u32 s81, s81, s79
  s_add_u32 m0, s80, 0
  s_add_u32 s44, s81, 0
  buffer_load_dwordx4 v11, s[8:11], s44 offen offset:0 lds
  buffer_load_dwordx4 v12, s[8:11], s44 offen offset:1024 lds
  v_mfma_f32_16x16x32_bf16 v[36:39], v[208:211], v[148:151], v[36:39]
  buffer_load_dwordx4 v13, s[8:11], s44 offen offset:2048 lds
  v_mfma_f32_16x16x32_bf16 v[40:43], v[208:211], v[152:155], v[40:43]
  buffer_load_dwordx4 v14, s[8:11], s44 offen offset:3072 lds
  v_mfma_f32_16x16x32_bf16 v[44:47], v[208:211], v[156:159], v[44:47]
  s_add_u32 s46, s85, 4
  s_and_b32 s46, s46, 7
  s_lshl_b32 s82, s46, 12
  s_lshl_b32 s84, s3, 3
  s_add_u32 s84, s84, s46
  s_add_u32 s82, s82, s78
  v_readfirstlane_b32 s46, v20
  s_nop 0
  s_or_b32 s83, s83, s46
  s_bitcmp1_b32 s83, s84
  s_cbranch_scc1 L_fok4
  L_fsp4:
  s_sleep 1
  global_load_dword v20, v22, s[94:95] sc1
  s_waitcnt vmcnt(0)
  v_readfirstlane_b32 s46, v20
  s_sub_u32 s86, s86, 1
  s_or_b32 s83, s83, s46
  s_cmp_eq_u32 s86, 0
  s_cbranch_scc1 L_fok4
  s_bitcmp1_b32 s83, s84
  s_cbranch_scc0 L_fsp4
  L_fok4:
  global_load_dword v20, v22, s[94:95] sc1
  v_mfma_f32_16x16x32_bf16 v[48:51], v[212:215], v[144:147], v[48:51]
  s_add_u32 s45, s82, 0
  buffer_load_dwordx4 v[128:131], v10, s[12:15], s45 offen sc1
  v_mfma_f32_16x16x32_bf16 v[52:55], v[212:215], v[148:151], v[52:55]
  s_add_u32 s45, s82, 131072
  buffer_load_dwordx4 v[132:135], v10, s[12:15], s45 offen sc1
  v_mfma_f32_16x16x32_bf16 v[56:59], v[212:215], v[152:155], v[56:59]
  s_add_u32 s45, s82, 262144
  buffer_load_dwordx4 v[136:139], v10, s[12:15], s45 offen sc1
  v_mfma_f32_16x16x32_bf16 v[60:63], v[212:215], v[156:159], v[60:63]
  s_add_u32 s45, s82, 393216
  buffer_load_dwordx4 v[140:143], v10, s[12:15], s45 offen sc1
  s_waitcnt vmcnt(40)
  v_mfma_f32_16x16x32_bf16 v[64:67], v[216:219], v[144:147], v[64:67]
  ds_read_b64_tr_b16 v[224:225], v16 offset:12288
  v_mfma_f32_16x16x32_bf16 v[68:71], v[216:219], v[148:151], v[68:71]
  ds_read_b64_tr_b16 v[226:227], v16 offset:14336
  v_mfma_f32_16x16x32_bf16 v[72:75], v[216:219], v[152:155], v[72:75]
  ds_read_b64_tr_b16 v[228:229], v17 offset:12288
  v_mfma_f32_16x16x32_bf16 v[76:79], v[216:219], v[156:159], v[76:79]
  ds_read_b64_tr_b16 v[230:231], v17 offset:14336
  v_mfma_f32_16x16x32_bf16 v[80:83], v[220:223], v[144:147], v[80:83]
  ds_read_b64_tr_b16 v[232:233], v18 offset:12288
  v_mfma_f32_16x16x32_bf16 v[84:87], v[220:223], v[148:151], v[84:87]
  ds_read_b64_tr_b16 v[234:235], v18 offset:14336
  v_mfma_f32_16x16x32_bf16 v[88:91], v[220:223], v[152:155], v[88:91]
  ds_read_b64_tr_b16 v[236:237], v19 offset:12288
  v_mfma_f32_16x16x32_bf16 v[92:95], v[220:223], v[156:159], v[92:95]
  ds_read_b64_tr_b16 v[238:239], v19 offset:14336
  s_waitcnt lgkmcnt(0)
  v_mfma_f32_16x16x32_bf16 v[32:35], v[224:227], v[160:163], v[32:35]
  s_add_u32 m0, s80, 4096
  s_add_u32 s44, s81, 36864
  buffer_load_dwordx4 v11, s[8:11], s44 offen offset:0 lds
  v_mfma_f32_16x16x32_bf16 v[36:39], v[224:227], v[164:167], v[36:39]
  buffer_load_dwordx4 v12, s[8:11], s44 offen offset:1024 lds
  v_mfma_f32_16x16x32_bf16 v[40:43], v[224:227], v[168:171], v[40:43]
  buffer_load_dwordx4 v13, s[8:11], s44 offen offset:2048 lds
  v_mfma_f32_16x16x32_bf16 v[44:47], v[224:227], v[172:175], v[44:47]
  buffer_load_dwordx4 v14, s[8:11], s44 offen offset:3072 lds
  v_mfma_f32_16x16x32_bf16 v[48:51], v[228:231], v[160:163], v[48:51]
  s_add_u32 s45, s82, 1024
  buffer_load_dwordx4 v[144:147], v10, s[12:15], s45 offen sc1
  v_mfma_f32_16x16x32_bf16 v[52:55], v[228:231], v[164:167], v[52:55]
  s_add_u32 s45, s82, 132096
  buffer_load_dwordx4 v[148:151], v10, s[12:15], s45 offen sc1
  v_mfma_f32_16x16x32_bf16 v[56:59], v[228:231], v[168:171], v[56:59]
  s_add_u32 s45, s82, 263168
  buffer_load_dwordx4 v[152:155], v10, s[12:15], s45 offen sc1
  v_mfma_f32_16x16x32_bf16 v[60:63], v[228:231], v[172:175], v[60:63]
  s_add_u32 s45, s82, 394240
  buffer_load_dwordx4 v[156:159], v10, s[12:15], s45 offen sc1
  s_waitcnt vmcnt(40)
  v_mfma_f32_16x16x32_bf16 v[64:67], v[232:235], v[160:163], v[64:67]
  ds_read_b64_tr_b16 v[208:209], v16 offset:16384
  v_mfma_f32_16x16x32_bf16 v[68:71], v[232:235], v[164:167], v[68:71]
  ds_read_b64_tr_b16 v[210:211], v16 offset:18432
  v_mfma_f32_16x16x32_bf16 v[72:75], v[232:235], v[168:171], v[72:75]
  ds_read_b64_tr_b16 v[212:213], v17 offset:16384
  v_mfma_f32_16x16x32_bf16 v[76:79], v[232:235], v[172:175], v[76:79]
  ds_read_b64_tr_b16 v[214:215], v17 offset:18432
  v_mfma_f32_16x16x32_bf16 v[80:83], v[236:239], v[160:163], v[80:83]
  ds_read_b64_tr_b16 v[216:217], v18 offset:16384
  v_mfma_f32_16x16x32_bf16 v[84:87], v[236:239], v[164:167], v[84:87]
  ds_read_b64_tr_b16 v[218:219], v18 offset:18432
  v_mfma_f32_16x16x32_bf16 v[88:91], v[236:239], v[168:171], v[88:91]
  ds_read_b64_tr_b16 v[220:221], v19 offset:16384
  v_mfma_f32_16x16x32_bf16 v[92:95], v[236:239], v[172:175], v[92:95]
  ds_read_b64_tr_b16 v[222:223], v19 offset:18432
  s_waitcnt lgkmcnt(0)
  v_mfma_f32_16x16x32_bf16 v[32:35], v[208:211], v[176:179], v[32:35]
  s_add_u32 m0, s80, 8192
  s_add_u32 s44, s81, 73728
  buffer_load_dwordx4 v11, s[8:11], s44 offen offset:0 lds
  v_mfma_f32_16x16x32_bf16 v[36:39], v[208:211], v[180:183], v[36:39]
  buffer_load_dwordx4 v12, s[8:11], s44 offen offset:1024 lds
  v_mfma_f32_16x16x32_bf16 v[40:43], v[208:211], v[184:187], v[40:43]
  buffer_load_dwordx4 v13, s[8:11], s44 offen offset:2048 lds
  v_mfma_f32_16x16x32_bf16 v[44:47], v[208:211], v[188:191], v[44:47]
  buffer_load_dwordx4 v14, s[8:11], s44 offen offset:3072 lds
  v_mfma_f32_16x16x32_bf16 v[48:51], v[212:215], v[176:179], v[48:51]
  s_add_u32 s45, s82, 2048
  buffer_load_dwordx4 v[160:163], v10, s[12:15], s45 offen sc1
  v_mfma_f32_16x16x32_bf16 v[52:55], v[212:215], v[180:183], v[52:55]
  s_add_u32 s45, s82, 133120
  buffer_load_dwordx4 v[164:167], v10, s[12:15], s45 offen sc1
  v_mfma_f32_16x16x32_bf16 v[56:59], v[212:215], v[184:187], v[56:59]
  s_add_u32 s45, s82, 264192
  buffer_load_dwordx4 v[168:171], v10, s[12:15], s45 offen sc1
  v_mfma_f32_16x16x32_bf16 v[60:63], v[212:215], v[188:191], v[60:63]
  s_add_u32 s45, s82, 395264
  buffer_load_dwordx4 v[172:175], v10, s[12:15], s45 offen sc1
  s_waitcnt vmcnt(40)
  v_mfma_f32_16x16x32_bf16 v[64:67], v[216:219], v[176:179], v[64:67]
  ds_read_b64_tr_b16 v[224:225], v16 offset:20480
  v_mfma_f32_16x16x32_bf16 v[68:71], v[216:219], v[180:183], v[68:71]
  ds_read_b64_tr_b16 v[226:227], v16 offset:22528
  v_mfma_f32_16x16x32_bf16 v[72:75], v[216:219], v[184:187], v[72:75]
  ds_read_b64_tr_b16 v[228:229], v17 offset:20480
  v_mfma_f32_16x16x32_bf16 v[76:79], v[216:219], v[188:191], v[76:79]
  ds_read_b64_tr_b16 v[230:231], v17 offset:22528
  v_mfma_f32_16x16x32_bf16 v[80:83], v[220:223], v[176:179], v[80:83]
  ds_read_b64_tr_b16 v[232:233], v18 offset:20480
  v_mfma_f32_16x16x32_bf16 v[84:87], v[220:223], v[180:183], v[84:87]
  ds_read_b64_tr_b16 v[234:235], v18 offset:22528
  v_mfma_f32_16x16x32_bf16 v[88:91], v[220:223], v[184:187], v[88:91]
  ds_read_b64_tr_b16 v[236:237], v19 offset:20480
  v_mfma_f32_16x16x32_bf16 v[92:95], v[220:223], v[188:191], v[92:95]
  ds_read_b64_tr_b16 v[238:239], v19 offset:22528
  s_waitcnt lgkmcnt(0)
  v_mfma_f32_16x16x32_bf16 v[32:35], v[224:227], v[192:195], v[32:35]
  s_add_u32 m0, s80, 12288
  s_add_u32 s44, s81, 110592
  buffer_load_dwordx4 v11, s[8:11], s44 offen offset:0 lds
  v_mfma_f32_16x16x32_bf16 v[36:39], v[224:227], v[196:199], v[36:39]
  buffer_load_dwordx4 v12, s[8:11], s44 offen offset:1024 lds
  v_mfma_f32_16x16x32_bf16 v[40:43], v[224:227], v[200:203], v[40:43]
  buffer_load_dwordx4 v13, s[8:11], s44 offen offset:2048 lds
  v_mfma_f32_16x16x32_bf16 v[44:47], v[224:227], v[204:207], v[44:47]
  buffer_load_dwordx4 v14, s[8:11], s44 offen offset:3072 lds
  v_mfma_f32_16x16x32_bf16 v[48:51], v[228:231], v[192:195], v[48:51]
  s_add_u32 s45, s82, 3072
  buffer_load_dwordx4 v[176:179], v10, s[12:15], s45 offen sc1
  v_mfma_f32_16x16x32_bf16 v[52:55], v[228:231], v[196:199], v[52:55]
  s_add_u32 s45, s82, 134144
  buffer_load_dwordx4 v[180:183], v10, s[12:15], s45 offen sc1
  v_mfma_f32_16x16x32_bf16 v[56:59], v[228:231], v[200:203], v[56:59]
  s_add_u32 s45, s82, 265216
  buffer_load_dwordx4 v[184:187], v10, s[12:15], s45 offen sc1
  v_mfma_f32_16x16x32_bf16 v[60:63], v[228:231], v[204:207], v[60:63]
  s_add_u32 s45, s82, 396288
  buffer_load_dwordx4 v[188:191], v10, s[12:15], s45 offen sc1
  s_waitcnt vmcnt(40)
  v_mfma_f32_16x16x32_bf16 v[64:67], v[232:235], v[192:195], v[64:67]
  ds_read_b64_tr_b16 v[208:209], v16 offset:24576
  v_mfma_f32_16x16x32_bf16 v[68:71], v[232:235], v[196:199], v[68:71]
  ds_read_b64_tr_b16 v[210:211], v16 offset:26624
  v_mfma_f32_16x16x32_bf16 v[72:75], v[232:235], v[200:203], v[72:75]
  ds_read_b64_tr_b16 v[212:213], v17 offset:24576
  v_mfma_f32_16x16x32_bf16 v[76:79], v[232:235], v[204:207], v[76:79]
  ds_read_b64_tr_b16 v[214:215], v17 offset:26624
  v_mfma_f32_16x16x32_bf16 v[80:83], v[236:239], v[192:195], v[80:83]
  ds_read_b64_tr_b16 v[216:217], v18 offset:24576
  v_mfma_f32_16x16x32_bf16 v[84:87], v[236:239], v[196:199], v[84:87]
  ds_read_b64_tr_b16 v[218:219], v18 offset:26624
  v_mfma_f32_16x16x32_bf16 v[88:91], v[236:239], v[200:203], v[88:91]
  ds_read_b64_tr_b16 v[220:221], v19 offset:24576
  v_mfma_f32_16x16x32_bf16 v[92:95], v[236:239], v[204:207], v[92:95]
  ds_read_b64_tr_b16 v[222:223], v19 offset:26624
  s_waitcnt lgkmcnt(0)
  v_mfma_f32_16x16x32_bf16 v[32:35], v[208:211], v[96:99], v[32:35]
  s_add_u32 s46, s85, 5
  s_and_b32 s46, s46, 7
  s_mul_i32 s81, s46, 147456
  s_add_u32 s81, s81, s79
  s_add_u32 m0, s80, 16384
  s_add_u32 s44, s81, 0
  buffer_load_dwordx4 v11, s[8:11], s44 offen offset:0 lds
  buffer_load_dwordx4 v12, s[8:11], s44 offen offset:1024 lds
  v_mfma_f32_16x16x32_bf16 v[36:39], v[208:211], v[100:103], v[36:39]
  buffer_load_dwordx4 v13, s[8:11], s44 offen offset:2048 lds
  v_mfma_f32_16x16x32_bf16 v[40:43], v[208:211], v[104:107], v[40:43]
  buffer_load_dwordx4 v14, s[8:11], s44 offen offset:3072 lds
  v_mfma_f32_16x16x32_bf16 v[44:47], v[208:211], v[108:111], v[44:47]
  s_add_u32 s46, s85, 5
  s_and_b32 s46, s46, 7
  s_lshl_b32 s82, s46, 12
  s_lshl_b32 s84, s3, 3
  s_add_u32 s84, s84, s46
  s_add_u32 s82, s82, s78
  v_readfirstlane_b32 s46, v21
  s_nop 0
  s_or_b32 s83, s83, s46
  s_bitcmp1_b32 s83, s84
  s_cbranch_scc1 L_fok5
  L_fsp5:
  s_sleep 1
  global_load_dword v21, v22, s[94:95] sc1
  s_waitcnt vmcnt(0)
  v_readfirstlane_b32 s46, v21
  s_sub_u32 s86, s86, 1
  s_or_b32 s83, s83, s46
  s_cmp_eq_u32 s86, 0
  s_cbranch_scc1 L_fok5
  s_bitcmp1_b32 s83, s84
  s_cbranch_scc0 L_fsp5
  L_fok5:
  global_load_dword v21, v22, s[94:95] sc1
  v_mfma_f32_16x16x32_bf16 v[48:51], v[212:215], v[96:99], v[48:51]
  s_add_u32 s45, s82, 0
  buffer_load_dwordx4 v[192:195], v10, s[12:15], s45 offen sc1
  v_mfma_f32_16x16x32_bf16 v[52:55], v[212:215], v[100:103], v[52:55]
  s_add_u32 s45, s82, 131072
  buffer_load_dwordx4 v[196:199], v10, s[12:15], s45 offen sc1
  v_mfma_f32_16x16x32_bf16 v[56:59], v[212:215], v[104:107], v[56:59]
  s_add_u32 s45, s82, 262144
  buffer_load_dwordx4 v[200:203], v10, s[12:15], s45 offen sc1
  v_mfma_f32_16x16x32_bf16 v[60:63], v[212:215], v[108:111], v[60:63]
  s_add_u32 s45, s82, 393216
  buffer_load_dwordx4 v[204:207], v10, s[12:15], s45 offen sc1
  s_waitcnt vmcnt(40)
  v_mfma_f32_16x16x32_bf16 v[64:67], v[216:219], v[96:99], v[64:67]
  ds_read_b64_tr_b16 v[224:225], v16 offset:28672
  v_mfma_f32_16x16x32_bf16 v[68:71], v[216:219], v[100:103], v[68:71]
  ds_read_b64_tr_b16 v[226:227], v16 offset:30720
  v_mfma_f32_16x16x32_bf16 v[72:75], v[216:219], v[104:107], v[72:75]
  ds_read_b64_tr_b16 v[228:229], v17 offset:28672
  v_mfma_f32_16x16x32_bf16 v[76:79], v[216:219], v[108:111], v[76:79]
  ds_read_b64_tr_b16 v[230:231], v17 offset:30720
  v_mfma_f32_16x16x32_bf16 v[80:83], v[220:223], v[96:99], v[80:83]
  ds_read_b64_tr_b16 v[232:233], v18 offset:28672
  v_mfma_f32_16x16x32_bf16 v[84:87], v[220:223], v[100:103], v[84:87]
  ds_read_b64_tr_b16 v[234:235], v18 offset:30720
  v_mfma_f32_16x16x32_bf16 v[88:91], v[220:223], v[104:107], v[88:91]
  ds_read_b64_tr_b16 v[236:237], v19 offset:28672
  v_mfma_f32_16x16x32_bf16 v[92:95], v[220:223], v[108:111], v[92:95]
  ds_read_b64_tr_b16 v[238:239], v19 offset:30720
  s_waitcnt lgkmcnt(0)
  v_mfma_f32_16x16x32_bf16 v[32:35], v[224:227], v[112:115], v[32:35]
  s_add_u32 m0, s80, 20480
  s_add_u32 s44, s81, 36864
  buffer_load_dwordx4 v11, s[8:11], s44 offen offset:0 lds
  v_mfma_f32_16x16x32_bf16 v[36:39], v[224:227], v[116:119], v[36:39]
  buffer_load_dwordx4 v12, s[8:11], s44 offen offset:1024 lds
  v_mfma_f32_16x16x32_bf16 v[40:43], v[224:227], v[120:123], v[40:43]
  buffer_load_dwordx4 v13, s[8:11], s44 offen offset:2048 lds
  v_mfma_f32_16x16x32_bf16 v[44:47], v[224:227], v[124:127], v[44:47]
  buffer_load_dwordx4 v14, s[8:11], s44 offen offset:3072 lds
  v_mfma_f32_16x16x32_bf16 v[48:51], v[228:231], v[112:115], v[48:51]
  s_add_u32 s45, s82, 1024
  buffer_load_dwordx4 v[96:99], v10, s[12:15], s45 offen sc1
  v_mfma_f32_16x16x32_bf16 v[52:55], v[228:231], v[116:119], v[52:55]
  s_add_u32 s45, s82, 132096
  buffer_load_dwordx4 v[100:103], v10, s[12:15], s45 offen sc1
  v_mfma_f32_16x16x32_bf16 v[56:59], v[228:231], v[120:123], v[56:59]
  s_add_u32 s45, s82, 263168
  buffer_load_dwordx4 v[104:107], v10, s[12:15], s45 offen sc1
  v_mfma_f32_16x16x32_bf16 v[60:63], v[228:231], v[124:127], v[60:63]
  s_add_u32 s45, s82, 394240
  buffer_load_dwordx4 v[108:111], v10, s[12:15], s45 offen sc1
  s_waitcnt vmcnt(40)
  v_mfma_f32_16x16x32_bf16 v[64:67], v[232:235], v[112:115], v[64:67]
  ds_read_b64_tr_b16 v[208:209], v16 offset:0
  v_mfma_f32_16x16x32_bf16 v[68:71], v[232:235], v[116:119], v[68:71]
  ds_read_b64_tr_b16 v[210:211], v16 offset:2048
  v_mfma_f32_16x16x32_bf16 v[72:75], v[232:235], v[120:123], v[72:75]
  ds_read_b64_tr_b16 v[212:213], v17 offset:0
  v_mfma_f32_16x16x32_bf16 v[76:79], v[232:235], v[124:127], v[76:79]
  ds_read_b64_tr_b16 v[214:215], v17 offset:2048
  v_mfma_f32_16x16x32_bf16 v[80:83], v[236:239], v[112:115], v[80:83]
  ds_read_b64_tr_b16 v[216:217], v18 offset:0
  v_mfma_f32_16x16x32_bf16 v[84:87], v[236:239], v[116:119], v[84:87]
  ds_read_b64_tr_b16 v[218:219], v18 offset:2048
  v_mfma_f32_16x16x32_bf16 v[88:91], v[236:239], v[120:123], v[88:91]
  ds_read_b64_tr_b16 v[220:221], v19 offset:0
  v_mfma_f32_16x16x32_bf16 v[92:95], v[236:239], v[124:127], v[92:95]
  ds_read_b64_tr_b16 v[222:223], v19 offset:2048
  s_waitcnt lgkmcnt(0)
  v_mfma_f32_16x16x32_bf16 v[32:35], v[208:211], v[128:131], v[32:35]
  s_add_u32 m0, s80, 24576
  s_add_u32 s44, s81, 73728
  buffer_load_dwordx4 v11, s[8:11], s44 offen offset:0 lds
  v_mfma_f32_16x16x32_bf16 v[36:39], v[208:211], v[132:135], v[36:39]
  buffer_load_dwordx4 v12, s[8:11], s44 offen offset:1024 lds
  v_mfma_f32_16x16x32_bf16 v[40:43], v[208:211], v[136:139], v[40:43]
  buffer_load_dwordx4 v13, s[8:11], s44 offen offset:2048 lds
  v_mfma_f32_16x16x32_bf16 v[44:47], v[208:211], v[140:143], v[44:47]
  buffer_load_dwordx4 v14, s[8:11], s44 offen offset:3072 lds
  v_mfma_f32_16x16x32_bf16 v[48:51], v[212:215], v[128:131], v[48:51]
  s_add_u32 s45, s82, 2048
  buffer_load_dwordx4 v[112:115], v10, s[12:15], s45 offen sc1
  v_mfma_f32_16x16x32_bf16 v[52:55], v[212:215], v[132:135], v[52:55]
  s_add_u32 s45, s82, 133120
  buffer_load_dwordx4 v[116:119], v10, s[12:15], s45 offen sc1
  v_mfma_f32_16x16x32_bf16 v[56:59], v[212:215], v[136:139], v[56:59]
  s_add_u32 s45, s82, 264192
  buffer_load_dwordx4 v[120:123], v10, s[12:15], s45 offen sc1
  v_mfma_f32_16x16x32_bf16 v[60:63], v[212:215], v[140:143], v[60:63]
  s_add_u32 s45, s82, 395264
  buffer_load_dwordx4 v[124:127], v10, s[12:15], s45 offen sc1
  s_waitcnt vmcnt(40)
  v_mfma_f32_16x16x32_bf16 v[64:67], v[216:219], v[128:131], v[64:67]
  ds_read_b64_tr_b16 v[224:225], v16 offset:4096
  v_mfma_f32_16x16x32_bf16 v[68:71], v[216:219], v[132:135], v[68:71]
  ds_read_b64_tr_b16 v[226:227], v16 offset:6144
  v_mfma_f32_16x16x32_bf16 v[72:75], v[216:219], v[136:139], v[72:75]
  ds_read_b64_tr_b16 v[228:229], v17 offset:4096
  v_mfma_f32_16x16x32_bf16 v[76:79], v[216:219], v[140:143], v[76:79]
  ds_read_b64_tr_b16 v[230:231], v17 offset:6144
  v_mfma_f32_16x16x32_bf16 v[80:83], v[220:223], v[128:131], v[80:83]
  ds_read_b64_tr_b16 v[232:233], v18 offset:4096
  v_mfma_f32_16x16x32_bf16 v[84:87], v[220:223], v[132:135], v[84:87]
  ds_read_b64_tr_b16 v[234:235], v18 offset:6144
  v_mfma_f32_16x16x32_bf16 v[88:91], v[220:223], v[136:139], v[88:91]
  ds_read_b64_tr_b16 v[236:237], v19 offset:4096
  v_mfma_f32_16x16x32_bf16 v[92:95], v[220:223], v[140:143], v[92:95]
  ds_read_b64_tr_b16 v[238:239], v19 offset:6144
  s_waitcnt lgkmcnt(0)
  v_mfma_f32_16x16x32_bf16 v[32:35], v[224:227], v[144:147], v[32:35]
  s_add_u32 m0, s80, 28672
  s_add_u32 s44, s81, 110592
  buffer_load_dwordx4 v11, s[8:11], s44 offen offset:0 lds
  v_mfma_f32_16x16x32_bf16 v[36:39], v[224:227], v[148:151], v[36:39]
  buffer_load_dwordx4 v12, s[8:11], s44 offen offset:1024 lds
  v_mfma_f32_16x16x32_bf16 v[40:43], v[224:227], v[152:155], v[40:43]
  buffer_load_dwordx4 v13, s[8:11], s44 offen offset:2048 lds
  v_mfma_f32_16x16x32_bf16 v[44:47], v[224:227], v[156:159], v[44:47]
  buffer_load_dwordx4 v14, s[8:11], s44 offen offset:3072 lds
  v_mfma_f32_16x16x32_bf16 v[48:51], v[228:231], v[144:147], v[48:51]
  s_add_u32 s45, s82, 3072
  buffer_load_dwordx4 v[128:131], v10, s[12:15], s45 offen sc1
  v_mfma_f32_16x16x32_bf16 v[52:55], v[228:231], v[148:151], v[52:55]
  s_add_u32 s45, s82, 134144
  buffer_load_dwordx4 v[132:135], v10, s[12:15], s45 offen sc1
  v_mfma_f32_16x16x32_bf16 v[56:59], v[228:231], v[152:155], v[56:59]
  s_add_u32 s45, s82, 265216
  buffer_load_dwordx4 v[136:139], v10, s[12:15], s45 offen sc1
  v_mfma_f32_16x16x32_bf16 v[60:63], v[228:231], v[156:159], v[60:63]
  s_add_u32 s45, s82, 396288
  buffer_load_dwordx4 v[140:143], v10, s[12:15], s45 offen sc1
  s_waitcnt vmcnt(40)
  v_mfma_f32_16x16x32_bf16 v[64:67], v[232:235], v[144:147], v[64:67]
  ds_read_b64_tr_b16 v[208:209], v16 offset:8192
  v_mfma_f32_16x16x32_bf16 v[68:71], v[232:235], v[148:151], v[68:71]
  ds_read_b64_tr_b16 v[210:211], v16 offset:10240
  v_mfma_f32_16x16x32_bf16 v[72:75], v[232:235], v[152:155], v[72:75]
  ds_read_b64_tr_b16 v[212:213], v17 offset:8192
  v_mfma_f32_16x16x32_bf16 v[76:79], v[232:235], v[156:159], v[76:79]
  ds_read_b64_tr_b16 v[214:215], v17 offset:10240
  v_mfma_f32_16x16x32_bf16 v[80:83], v[236:239], v[144:147], v[80:83]
  ds_read_b64_tr_b16 v[216:217], v18 offset:8192
  v_mfma_f32_16x16x32_bf16 v[84:87], v[236:239], v[148:151], v[84:87]
  ds_read_b64_tr_b16 v[218:219], v18 offset:10240
  v_mfma_f32_16x16x32_bf16 v[88:91], v[236:239], v[152:155], v[88:91]
  ds_read_b64_tr_b16 v[220:221], v19 offset:8192
  v_mfma_f32_16x16x32_bf16 v[92:95], v[236:239], v[156:159], v[92:95]
  ds_read_b64_tr_b16 v[222:223], v19 offset:10240
  s_waitcnt lgkmcnt(0)
  v_mfma_f32_16x16x32_bf16 v[32:35], v[208:211], v[160:163], v[32:35]
  s_add_u32 s46, s85, 6
  s_and_b32 s46, s46, 7
  s_mul_i32 s81, s46, 147456
  s_add_u32 s81, s81, s79
  s_add_u32 m0, s80, 0
  s_add_u32 s44, s81, 0
  buffer_load_dwordx4 v11, s[8:11], s44 offen offset:0 lds
  buffer_load_dwordx4 v12, s[8:11], s44 offen offset:1024 lds
  v_mfma_f32_16x16x32_bf16 v[36:39], v[208:211], v[164:167], v[36:39]
  buffer_load_dwordx4 v13, s[8:11], s44 offen offset:2048 lds
  v_mfma_f32_16x16x32_bf16 v[40:43], v[208:211], v[168:171], v[40:43]
  buffer_load_dwordx4 v14, s[8:11], s44 offen offset:3072 lds
  v_mfma_f32_16x16x32_bf16 v[44:47], v[208:211], v[172:175], v[44:47]
  s_add_u32 s46, s85, 6
  s_and_b32 s46, s46, 7
  s_lshl_b32 s82, s46, 12
  s_lshl_b32 s84, s3, 3
  s_add_u32 s84, s84, s46
  s_add_u32 s82, s82, s78
  v_readfirstlane_b32 s46, v20
  s_nop 0
  s_or_b32 s83, s83, s46
  s_bitcmp1_b32 s83, s84
  s_cbranch_scc1 L_fok6
  L_fsp6:
  s_sleep 1
  global_load_dword v20, v22, s[94:95] sc1
  s_waitcnt vmcnt(0)
  v_readfirstlane_b32 s46, v20
  s_sub_u32 s86, s86, 1
  s_or_b32 s83, s83, s46
  s_cmp_eq_u32 s86, 0
  s_cbranch_scc1 L_fok6
  s_bitcmp1_b32 s83, s84
  s_cbranch_scc0 L_fsp6
  L_fok6:
  v_mfma_f32_16x16x32_bf16 v[48:51], v[212:215], v[160:163], v[48:51]
  s_add_u32 s45, s82, 0
  buffer_load_dwordx4 v[144:147], v10, s[12:15], s45 offen sc1
  v_mfma_f32_16x16x32_bf16 v[52:55], v[212:215], v[164:167], v[52:55]
  s_add_u32 s45, s82, 131072
  buffer_load_dwordx4 v[148:151], v10, s[12:15], s45 offen sc1
  v_mfma_f32_16x16x32_bf16 v[56:59], v[212:215], v[168:171], v[56:59]
  s_add_u32 s45, s82, 262144
  buffer_load_dwordx4 v[152:155], v10, s[12:15], s45 offen sc1
  v_mfma_f32_16x16x32_bf16 v[60:63], v[212:215], v[172:175], v[60:63]
  s_add_u32 s45, s82, 393216
  buffer_load_dwordx4 v[156:159], v10, s[12:15], s45 offen sc1
  s_waitcnt vmcnt(40)
  v_mfma_f32_16x16x32_bf16 v[64:67], v[216:219], v[160:163], v[64:67]
  ds_read_b64_tr_b16 v[224:225], v16 offset:12288
  v_mfma_f32_16x16x32_bf16 v[68:71], v[216:219], v[164:167], v[68:71]
  ds_read_b64_tr_b16 v[226:227], v16 offset:14336
  v_mfma_f32_16x16x32_bf16 v[72:75], v[216:219], v[168:171], v[72:75]
  ds_read_b64_tr_b16 v[228:229], v17 offset:12288
  v_mfma_f32_16x16x32_bf16 v[76:79], v[216:219], v[172:175], v[76:79]
  ds_read_b64_tr_b16 v[230:231], v17 offset:14336
  v_mfma_f32_16x16x32_bf16 v[80:83], v[220:223], v[160:163], v[80:83]
  ds_read_b64_tr_b16 v[232:233], v18 offset:12288
  v_mfma_f32_16x16x32_bf16 v[84:87], v[220:223], v[164:167], v[84:87]
  ds_read_b64_tr_b16 v[234:235], v18 offset:14336
  v_mfma_f32_16x16x32_bf16 v[88:91], v[220:223], v[168:171], v[88:91]
  ds_read_b64_tr_b16 v[236:237], v19 offset:12288
  v_mfma_f32_16x16x32_bf16 v[92:95], v[220:223], v[172:175], v[92:95]
  ds_read_b64_tr_b16 v[238:239], v19 offset:14336
  s_waitcnt lgkmcnt(0)
  v_mfma_f32_16x16x32_bf16 v[32:35], v[224:227], v[176:179], v[32:35]
  s_add_u32 m0, s80, 4096
  s_add_u32 s44, s81, 36864
  buffer_load_dwordx4 v11, s[8:11], s44 offen offset:0 lds
  v_mfma_f32_16x16x32_bf16 v[36:39], v[224:227], v[180:183], v[36:39]
  buffer_load_dwordx4 v12, s[8:11], s44 offen offset:1024 lds
  v_mfma_f32_16x16x32_bf16 v[40:43], v[224:227], v[184:187], v[40:43]
  buffer_load_dwordx4 v13, s[8:11], s44 offen offset:2048 lds
  v_mfma_f32_16x16x32_bf16 v[44:47], v[224:227], v[188:191], v[44:47]
  buffer_load_dwordx4 v14, s[8:11], s44 offen offset:3072 lds
  v_mfma_f32_16x16x32_bf16 v[48:51], v[228:231], v[176:179], v[48:51]
  s_add_u32 s45, s82, 1024
  buffer_load_dwordx4 v[160:163], v10, s[12:15], s45 offen sc1
  v_mfma_f32_16x16x32_bf16 v[52:55], v[228:231], v[180:183], v[52:55]
  s_add_u32 s45, s82, 132096
  buffer_load_dwordx4 v[164:167], v10, s[12:15], s45 offen sc1
  v_mfma_f32_16x16x32_bf16 v[56:59], v[228:231], v[184:187], v[56:59]
  s_add_u32 s45, s82, 263168
  buffer_load_dwordx4 v[168:171], v10, s[12:15], s45 offen sc1
  v_mfma_f32_16x16x32_bf16 v[60:63], v[228:231], v[188:191], v[60:63]
  s_add_u32 s45, s82, 394240
  buffer_load_dwordx4 v[172:175], v10, s[12:15], s45 offen sc1
  s_waitcnt vmcnt(40)
  v_mfma_f32_16x16x32_bf16 v[64:67], v[232:235], v[176:179], v[64:67]
  ds_read_b64_tr_b16 v[208:209], v16 offset:16384
  v_mfma_f32_16x16x32_bf16 v[68:71], v[232:235], v[180:183], v[68:71]
  ds_read_b64_tr_b16 v[210:211], v16 offset:18432
  v_mfma_f32_16x16x32_bf16 v[72:75], v[232:235], v[184:187], v[72:75]
  ds_read_b64_tr_b16 v[212:213], v17 offset:16384
  v_mfma_f32_16x16x32_bf16 v[76:79], v[232:235], v[188:191], v[76:79]
  ds_read_b64_tr_b16 v[214:215], v17 offset:18432
  v_mfma_f32_16x16x32_bf16 v[80:83], v[236:239], v[176:179], v[80:83]
  ds_read_b64_tr_b16 v[216:217], v18 offset:16384
  v_mfma_f32_16x16x32_bf16 v[84:87], v[236:239], v[180:183], v[84:87]
  ds_read_b64_tr_b16 v[218:219], v18 offset:18432
  v_mfma_f32_16x16x32_bf16 v[88:91], v[236:239], v[184:187], v[88:91]
  ds_read_b64_tr_b16 v[220:221], v19 offset:16384
  v_mfma_f32_16x16x32_bf16 v[92:95], v[236:239], v[188:191], v[92:95]
  ds_read_b64_tr_b16 v[222:223], v19 offset:18432
  s_waitcnt lgkmcnt(0)
  v_mfma_f32_16x16x32_bf16 v[32:35], v[208:211], v[192:195], v[32:35]
  s_add_u32 m0, s80, 8192
  s_add_u32 s44, s81, 73728
  buffer_load_dwordx4 v11, s[8:11], s44 offen offset:0 lds
  v_mfma_f32_16x16x32_bf16 v[36:39], v[208:211], v[196:199], v[36:39]
  buffer_load_dwordx4 v12, s[8:11], s44 offen offset:1024 lds
  v_mfma_f32_16x16x32_bf16 v[40:43], v[208:211], v[200:203], v[40:43]
  buffer_load_dwordx4 v13, s[8:11], s44 offen offset:2048 lds
  v_mfma_f32_16x16x32_bf16 v[44:47], v[208:211], v[204:207], v[44:47]
  buffer_load_dwordx4 v14, s[8:11], s44 offen offset:3072 lds
  v_mfma_f32_16x16x32_bf16 v[48:51], v[212:215], v[192:195], v[48:51]
  s_add_u32 s45, s82, 2048
  buffer_load_dwordx4 v[176:179], v10, s[12:15], s45 offen sc1
  v_mfma_f32_16x16x32_bf16 v[52:55], v[212:215], v[196:199], v[52:55]
  s_add_u32 s45, s82, 133120
  buffer_load_dwordx4 v[180:183], v10, s[12:15], s45 offen sc1
  v_mfma_f32_16x16x32_bf16 v[56:59], v[212:215], v[200:203], v[56:59]
  s_add_u32 s45, s82, 264192
  buffer_load_dwordx4 v[184:187], v10, s[12:15], s45 offen sc1
  v_mfma_f32_16x16x32_bf16 v[60:63], v[212:215], v[204:207], v[60:63]
  s_add_u32 s45, s82, 395264
  buffer_load_dwordx4 v[188:191], v10, s[12:15], s45 offen sc1
  s_waitcnt vmcnt(40)
  v_mfma_f32_16x16x32_bf16 v[64:67], v[216:219], v[192:195], v[64:67]
  ds_read_b64_tr_b16 v[224:225], v16 offset:20480
  v_mfma_f32_16x16x32_bf16 v[68:71], v[216:219], v[196:199], v[68:71]
  ds_read_b64_tr_b16 v[226:227], v16 offset:22528
  v_mfma_f32_16x16x32_bf16 v[72:75], v[216:219], v[200:203], v[72:75]
  ds_read_b64_tr_b16 v[228:229], v17 offset:20480
  v_mfma_f32_16x16x32_bf16 v[76:79], v[216:219], v[204:207], v[76:79]
  ds_read_b64_tr_b16 v[230:231], v17 offset:22528
  v_mfma_f32_16x16x32_bf16 v[80:83], v[220:223], v[192:195], v[80:83]
  ds_read_b64_tr_b16 v[232:233], v18 offset:20480
  v_mfma_f32_16x16x32_bf16 v[84:87], v[220:223], v[196:199], v[84:87]
  ds_read_b64_tr_b16 v[234:235], v18 offset:22528
  v_mfma_f32_16x16x32_bf16 v[88:91], v[220:223], v[200:203], v[88:91]
  ds_read_b64_tr_b16 v[236:237], v19 offset:20480
  v_mfma_f32_16x16x32_bf16 v[92:95], v[220:223], v[204:207], v[92:95]
  ds_read_b64_tr_b16 v[238:239], v19 offset:22528
  s_waitcnt lgkmcnt(0)
  v_mfma_f32_16x16x32_bf16 v[32:35], v[224:227], v[96:99], v[32:35]
  s_add_u32 m0, s80, 12288
  s_add_u32 s44, s81, 110592
  buffer_load_dwordx4 v11, s[8:11], s44 offen offset:0 lds
  v_mfma_f32_16x16x32_bf16 v[36:39], v[224:227], v[100:103], v[36:39]
  buffer_load_dwordx4 v12, s[8:11], s44 offen offset:1024 lds
  v_mfma_f32_16x16x32_bf16 v[40:43], v[224:227], v[104:107], v[40:43]
  buffer_load_dwordx4 v13, s[8:11], s44 offen offset:2048 lds
  v_mfma_f32_16x16x32_bf16 v[44:47], v[224:227], v[108:111], v[44:47]
  buffer_load_dwordx4 v14, s[8:11], s44 offen offset:3072 lds
  v_mfma_f32_16x16x32_bf16 v[48:51], v[228:231], v[96:99], v[48:51]
  s_add_u32 s45, s82, 3072
  buffer_load_dwordx4 v[192:195], v10, s[12:15], s45 offen sc1
  v_mfma_f32_16x16x32_bf16 v[52:55], v[228:231], v[100:103], v[52:55]
  s_add_u32 s45, s82, 134144
  buffer_load_dwordx4 v[196:199], v10, s[12:15], s45 offen sc1
  v_mfma_f32_16x16x32_bf16 v[56:59], v[228:231], v[104:107], v[56:59]
  s_add_u32 s45, s82, 265216
  buffer_load_dwordx4 v[200:203], v10, s[12:15], s45 offen sc1
  v_mfma_f32_16x16x32_bf16 v[60:63], v[228:231], v[108:111], v[60:63]
  s_add_u32 s45, s82, 396288
  buffer_load_dwordx4 v[204:207], v10, s[12:15], s45 offen sc1
  s_waitcnt vmcnt(40)
  v_mfma_f32_16x16x32_bf16 v[64:67], v[232:235], v[96:99], v[64:67]
  ds_read_b64_tr_b16 v[208:209], v16 offset:24576
  v_mfma_f32_16x16x32_bf16 v[68:71], v[232:235], v[100:103], v[68:71]
  ds_read_b64_tr_b16 v[210:211], v16 offset:26624
  v_mfma_f32_16x16x32_bf16 v[72:75], v[232:235], v[104:107], v[72:75]
  ds_read_b64_tr_b16 v[212:213], v17 offset:24576
  v_mfma_f32_16x16x32_bf16 v[76:79], v[232:235], v[108:111], v[76:79]
  ds_read_b64_tr_b16 v[214:215], v17 offset:26624
  v_mfma_f32_16x16x32_bf16 v[80:83], v[236:239], v[96:99], v[80:83]
  ds_read_b64_tr_b16 v[216:217], v18 offset:24576
  v_mfma_f32_16x16x32_bf16 v[84:87], v[236:239], v[100:103], v[84:87]
  ds_read_b64_tr_b16 v[218:219], v18 offset:26624
  v_mfma_f32_16x16x32_bf16 v[88:91], v[236:239], v[104:107], v[88:91]
  ds_read_b64_tr_b16 v[220:221], v19 offset:24576
  v_mfma_f32_16x16x32_bf16 v[92:95], v[236:239], v[108:111], v[92:95]
  ds_read_b64_tr_b16 v[222:223], v19 offset:26624
  s_waitcnt lgkmcnt(0)
  v_mfma_f32_16x16x32_bf16 v[32:35], v[208:211], v[112:115], v[32:35]
  s_add_u32 s46, s85, 7
  s_and_b32 s46, s46, 7
  s_mul_i32 s81, s46, 147456
  s_add_u32 s81, s81, s79
  s_add_u32 m0, s80, 16384
  s_add_u32 s44, s81, 0
  buffer_load_dwordx4 v11, s[8:11], s44 offen offset:0 lds
  buffer_load_dwordx4 v12, s[8:11], s44 offen offset:1024 lds
  v_mfma_f32_16x16x32_bf16 v[36:39], v[208:211], v[116:119], v[36:39]
  buffer_load_dwordx4 v13, s[8:11], s44 offen offset:2048 lds
  v_mfma_f32_16x16x32_bf16 v[40:43], v[208:211], v[120:123], v[40:43]
  buffer_load_dwordx4 v14, s[8:11], s44 offen offset:3072 lds
  v_mfma_f32_16x16x32_bf16 v[44:47], v[208:211], v[124:127], v[44:47]
  s_add_u32 s46, s85, 7
  s_and_b32 s46, s46, 7
  s_lshl_b32 s82, s46, 12
  s_lshl_b32 s84, s3, 3
  s_add_u32 s84, s84, s46
  s_add_u32 s82, s82, s78
  v_readfirstlane_b32 s46, v21
  s_nop 0
  s_or_b32 s83, s83, s46
  s_bitcmp1_b32 s83, s84
  s_cbranch_scc1 L_fok7
  L_fsp7:
  s_sleep 1
  global_load_dword v21, v22, s[94:95] sc1
  s_waitcnt vmcnt(0)
  v_readfirstlane_b32 s46, v21
  s_sub_u32 s86, s86, 1
  s_or_b32 s83, s83, s46
  s_cmp_eq_u32 s86, 0
  s_cbranch_scc1 L_fok7
  s_bitcmp1_b32 s83, s84
  s_cbranch_scc0 L_fsp7
  L_fok7:
  v_mfma_f32_16x16x32_bf16 v[48:51], v[212:215], v[112:115], v[48:51]
  s_add_u32 s45, s82, 0
  buffer_load_dwordx4 v[96:99], v10, s[12:15], s45 offen sc1
  v_mfma_f32_16x16x32_bf16 v[52:55], v[212:215], v[116:119], v[52:55]
  s_add_u32 s45, s82, 131072
  buffer_load_dwordx4 v[100:103], v10, s[12:15], s45 offen sc1
  v_mfma_f32_16x16x32_bf16 v[56:59], v[212:215], v[120:123], v[56:59]
  s_add_u32 s45, s82, 262144
  buffer_load_dwordx4 v[104:107], v10, s[12:15], s45 offen sc1
  v_mfma_f32_16x16x32_bf16 v[60:63], v[212:215], v[124:127], v[60:63]
  s_add_u32 s45, s82, 393216
  buffer_load_dwordx4 v[108:111], v10, s[12:15], s45 offen sc1
  s_waitcnt vmcnt(40)
  v_mfma_f32_16x16x32_bf16 v[64:67], v[216:219], v[112:115], v[64:67]
  ds_read_b64_tr_b16 v[224:225], v16 offset:28672
  v_mfma_f32_16x16x32_bf16 v[68:71], v[216:219], v[116:119], v[68:71]
  ds_read_b64_tr_b16 v[226:227], v16 offset:30720
  v_mfma_f32_16x16x32_bf16 v[72:75], v[216:219], v[120:123], v[72:75]
  ds_read_b64_tr_b16 v[228:229], v17 offset:28672
  v_mfma_f32_16x16x32_bf16 v[76:79], v[216:219], v[124:127], v[76:79]
  ds_read_b64_tr_b16 v[230:231], v17 offset:30720
  v_mfma_f32_16x16x32_bf16 v[80:83], v[220:223], v[112:115], v[80:83]
  ds_read_b64_tr_b16 v[232:233], v18 offset:28672
  v_mfma_f32_16x16x32_bf16 v[84:87], v[220:223], v[116:119], v[84:87]
  ds_read_b64_tr_b16 v[234:235], v18 offset:30720
  v_mfma_f32_16x16x32_bf16 v[88:91], v[220:223], v[120:123], v[88:91]
  ds_read_b64_tr_b16 v[236:237], v19 offset:28672
  v_mfma_f32_16x16x32_bf16 v[92:95], v[220:223], v[124:127], v[92:95]
  ds_read_b64_tr_b16 v[238:239], v19 offset:30720
  s_waitcnt lgkmcnt(0)
  v_mfma_f32_16x16x32_bf16 v[32:35], v[224:227], v[128:131], v[32:35]
  s_add_u32 m0, s80, 20480
  s_add_u32 s44, s81, 36864
  buffer_load_dwordx4 v11, s[8:11], s44 offen offset:0 lds
  v_mfma_f32_16x16x32_bf16 v[36:39], v[224:227], v[132:135], v[36:39]
  buffer_load_dwordx4 v12, s[8:11], s44 offen offset:1024 lds
  v_mfma_f32_16x16x32_bf16 v[40:43], v[224:227], v[136:139], v[40:43]
  buffer_load_dwordx4 v13, s[8:11], s44 offen offset:2048 lds
  v_mfma_f32_16x16x32_bf16 v[44:47], v[224:227], v[140:143], v[44:47]
  buffer_load_dwordx4 v14, s[8:11], s44 offen offset:3072 lds
  v_mfma_f32_16x16x32_bf16 v[48:51], v[228:231], v[128:131], v[48:51]
  s_add_u32 s45, s82, 1024
  buffer_load_dwordx4 v[112:115], v10, s[12:15], s45 offen sc1
  v_mfma_f32_16x16x32_bf16 v[52:55], v[228:231], v[132:135], v[52:55]
  s_add_u32 s45, s82, 132096
  buffer_load_dwordx4 v[116:119], v10, s[12:15], s45 offen sc1
  v_mfma_f32_16x16x32_bf16 v[56:59], v[228:231], v[136:139], v[56:59]
  s_add_u32 s45, s82, 263168
  buffer_load_dwordx4 v[120:123], v10, s[12:15], s45 offen sc1
  v_mfma_f32_16x16x32_bf16 v[60:63], v[228:231], v[140:143], v[60:63]
  s_add_u32 s45, s82, 394240
  buffer_load_dwordx4 v[124:127], v10, s[12:15], s45 offen sc1
  s_waitcnt vmcnt(40)
  v_mfma_f32_16x16x32_bf16 v[64:67], v[232:235], v[128:131], v[64:67]
  ds_read_b64_tr_b16 v[208:209], v16 offset:0
  v_mfma_f32_16x16x32_bf16 v[68:71], v[232:235], v[132:135], v[68:71]
  ds_read_b64_tr_b16 v[210:211], v16 offset:2048
  v_mfma_f32_16x16x32_bf16 v[72:75], v[232:235], v[136:139], v[72:75]
  ds_read_b64_tr_b16 v[212:213], v17 offset:0
  v_mfma_f32_16x16x32_bf16 v[76:79], v[232:235], v[140:143], v[76:79]
  ds_read_b64_tr_b16 v[214:215], v17 offset:2048
  v_mfma_f32_16x16x32_bf16 v[80:83], v[236:239], v[128:131], v[80:83]
  ds_read_b64_tr_b16 v[216:217], v18 offset:0
  v_mfma_f32_16x16x32_bf16 v[84:87], v[236:239], v[132:135], v[84:87]
  ds_read_b64_tr_b16 v[218:219], v18 offset:2048
  v_mfma_f32_16x16x32_bf16 v[88:91], v[236:239], v[136:139], v[88:91]
  ds_read_b64_tr_b16 v[220:221], v19 offset:0
  v_mfma_f32_16x16x32_bf16 v[92:95], v[236:239], v[140:143], v[92:95]
  ds_read_b64_tr_b16 v[222:223], v19 offset:2048
  s_waitcnt lgkmcnt(0)
  v_mfma_f32_16x16x32_bf16 v[32:35], v[208:211], v[144:147], v[32:35]
  s_add_u32 m0, s80, 24576
  s_add_u32 s44, s81, 73728
  buffer_load_dwordx4 v11, s[8:11], s44 offen offset:0 lds
  v_mfma_f32_16x16x32_bf16 v[36:39], v[208:211], v[148:151], v[36:39]
  buffer_load_dwordx4 v12, s[8:11], s44 offen offset:1024 lds
  v_mfma_f32_16x16x32_bf16 v[40:43], v[208:211], v[152:155], v[40:43]
  buffer_load_dwordx4 v13, s[8:11], s44 offen offset:2048 lds
  v_mfma_f32_16x16x32_bf16 v[44:47], v[208:211], v[156:159], v[44:47]
  buffer_load_dwordx4 v14, s[8:11], s44 offen offset:3072 lds
  v_mfma_f32_16x16x32_bf16 v[48:51], v[212:215], v[144:147], v[48:51]
  s_add_u32 s45, s82, 2048
  buffer_load_dwordx4 v[128:131], v10, s[12:15], s45 offen sc1
  v_mfma_f32_16x16x32_bf16 v[52:55], v[212:215], v[148:151], v[52:55]
  s_add_u32 s45, s82, 133120
  buffer_load_dwordx4 v[132:135], v10, s[12:15], s45 offen sc1
  v_mfma_f32_16x16x32_bf16 v[56:59], v[212:215], v[152:155], v[56:59]
  s_add_u32 s45, s82, 264192
  buffer_load_dwordx4 v[136:139], v10, s[12:15], s45 offen sc1
  v_mfma_f32_16x16x32_bf16 v[60:63], v[212:215], v[156:159], v[60:63]
  s_add_u32 s45, s82, 395264
  buffer_load_dwordx4 v[140:143], v10, s[12:15], s45 offen sc1
  s_waitcnt vmcnt(40)
  v_mfma_f32_16x16x32_bf16 v[64:67], v[216:219], v[144:147], v[64:67]
  ds_read_b64_tr_b16 v[224:225], v16 offset:4096
  v_mfma_f32_16x16x32_bf16 v[68:71], v[216:219], v[148:151], v[68:71]
  ds_read_b64_tr_b16 v[226:227], v16 offset:6144
  v_mfma_f32_16x16x32_bf16 v[72:75], v[216:219], v[152:155], v[72:75]
  ds_read_b64_tr_b16 v[228:229], v17 offset:4096
  v_mfma_f32_16x16x32_bf16 v[76:79], v[216:219], v[156:159], v[76:79]
  ds_read_b64_tr_b16 v[230:231], v17 offset:6144
  v_mfma_f32_16x16x32_bf16 v[80:83], v[220:223], v[144:147], v[80:83]
  ds_read_b64_tr_b16 v[232:233], v18 offset:4096
  v_mfma_f32_16x16x32_bf16 v[84:87], v[220:223], v[148:151], v[84:87]
  ds_read_b64_tr_b16 v[234:235], v18 offset:6144
  v_mfma_f32_16x16x32_bf16 v[88:91], v[220:223], v[152:155], v[88:91]
  ds_read_b64_tr_b16 v[236:237], v19 offset:4096
  v_mfma_f32_16x16x32_bf16 v[92:95], v[220:223], v[156:159], v[92:95]
  ds_read_b64_tr_b16 v[238:239], v19 offset:6144
  s_waitcnt lgkmcnt(0)
  v_mfma_f32_16x16x32_bf16 v[32:35], v[224:227], v[160:163], v[32:35]
  s_add_u32 m0, s80, 28672
  s_add_u32 s44, s81, 110592
  buffer_load_dwordx4 v11, s[8:11], s44 offen offset:0 lds
  v_mfma_f32_16x16x32_bf16 v[36:39], v[224:227], v[164:167], v[36:39]
  buffer_load_dwordx4 v12, s[8:11], s44 offen offset:1024 lds
  v_mfma_f32_16x16x32_bf16 v[40:43], v[224:227], v[168:171], v[40:43]
  buffer_load_dwordx4 v13, s[8:11], s44 offen offset:2048 lds
  v_mfma_f32_16x16x32_bf16 v[44:47], v[224:227], v[172:175], v[44:47]
  buffer_load_dwordx4 v14, s[8:11], s44 offen offset:3072 lds
  v_mfma_f32_16x16x32_bf16 v[48:51], v[228:231], v[160:163], v[48:51]
  s_add_u32 s45, s82, 3072
  buffer_load_dwordx4 v[144:147], v10, s[12:15], s45 offen sc1
  v_mfma_f32_16x16x32_bf16 v[52:55], v[228:231], v[164:167], v[52:55]
  s_add_u32 s45, s82, 134144
  buffer_load_dwordx4 v[148:151], v10, s[12:15], s45 offen sc1
  v_mfma_f32_16x16x32_bf16 v[56:59], v[228:231], v[168:171], v[56:59]
  s_add_u32 s45, s82, 265216
  buffer_load_dwordx4 v[152:155], v10, s[12:15], s45 offen sc1
  v_mfma_f32_16x16x32_bf16 v[60:63], v[228:231], v[172:175], v[60:63]
  s_add_u32 s45, s82, 396288
  buffer_load_dwordx4 v[156:159], v10, s[12:15], s45 offen sc1
  s_waitcnt vmcnt(40)
  v_mfma_f32_16x16x32_bf16 v[64:67], v[232:235], v[160:163], v[64:67]
  ds_read_b64_tr_b16 v[208:209], v16 offset:8192
  v_mfma_f32_16x16x32_bf16 v[68:71], v[232:235], v[164:167], v[68:71]
  ds_read_b64_tr_b16 v[210:211], v16 offset:10240
  v_mfma_f32_16x16x32_bf16 v[72:75], v[232:235], v[168:171], v[72:75]
  ds_read_b64_tr_b16 v[212:213], v17 offset:8192
  v_mfma_f32_16x16x32_bf16 v[76:79], v[232:235], v[172:175], v[76:79]
  ds_read_b64_tr_b16 v[214:215], v17 offset:10240
  v_mfma_f32_16x16x32_bf16 v[80:83], v[236:239], v[160:163], v[80:83]
  ds_read_b64_tr_b16 v[216:217], v18 offset:8192
  v_mfma_f32_16x16x32_bf16 v[84:87], v[236:239], v[164:167], v[84:87]
  ds_read_b64_tr_b16 v[218:219], v18 offset:10240
  v_mfma_f32_16x16x32_bf16 v[88:91], v[236:239], v[168:171], v[88:91]
  ds_read_b64_tr_b16 v[220:221], v19 offset:8192
  v_mfma_f32_16x16x32_bf16 v[92:95], v[236:239], v[172:175], v[92:95]
  ds_read_b64_tr_b16 v[222:223], v19 offset:10240
  s_waitcnt lgkmcnt(0)
  v_mfma_f32_16x16x32_bf16 v[32:35], v[208:211], v[176:179], v[32:35]
  v_mfma_f32_16x16x32_bf16 v[36:39], v[208:211], v[180:183], v[36:39]
  v_mfma_f32_16x16x32_bf16 v[40:43], v[208:211], v[184:187], v[40:43]
  v_mfma_f32_16x16x32_bf16 v[44:47], v[208:211], v[188:191], v[44:47]
  v_mfma_f32_16x16x32_bf16 v[48:51], v[212:215], v[176:179], v[48:51]
  v_mfma_f32_16x16x32_bf16 v[52:55], v[212:215], v[180:183], v[52:55]
  v_mfma_f32_16x16x32_bf16 v[56:59], v[212:215], v[184:187], v[56:59]
  v_mfma_f32_16x16x32_bf16 v[60:63], v[212:215], v[188:191], v[60:63]
  s_waitcnt vmcnt(32)
  v_mfma_f32_16x16x32_bf16 v[64:67], v[216:219], v[176:179], v[64:67]
  ds_read_b64_tr_b16 v[224:225], v16 offset:12288
  v_mfma_f32_16x16x32_bf16 v[68:71], v[216:219], v[180:183], v[68:71]
  ds_read_b64_tr_b16 v[226:227], v16 offset:14336
  v_mfma_f32_16x16x32_bf16 v[72:75], v[216:219], v[184:187], v[72:75]
  ds_read_b64_tr_b16 v[228:229], v17 offset:12288
  v_mfma_f32_16x16x32_bf16 v[76:79], v[216:219], v[188:191], v[76:79]
  ds_read_b64_tr_b16 v[230:231], v17 offset:14336
  v_mfma_f32_16x16x32_bf16 v[80:83], v[220:223], v[176:179], v[80:83]
  ds_read_b64_tr_b16 v[232:233], v18 offset:12288
  v_mfma_f32_16x16x32_bf16 v[84:87], v[220:223], v[180:183], v[84:87]
  ds_read_b64_tr_b16 v[234:235], v18 offset:14336
  v_mfma_f32_16x16x32_bf16 v[88:91], v[220:223], v[184:187], v[88:91]
  ds_read_b64_tr_b16 v[236:237], v19 offset:12288
  v_mfma_f32_16x16x32_bf16 v[92:95], v[220:223], v[188:191], v[92:95]
  ds_read_b64_tr_b16 v[238:239], v19 offset:14336
  s_waitcnt lgkmcnt(0)
  v_mfma_f32_16x16x32_bf16 v[32:35], v[224:227], v[192:195], v[32:35]
  v_mfma_f32_16x16x32_bf16 v[36:39], v[224:227], v[196:199], v[36:39]
  v_mfma_f32_16x16x32_bf16 v[40:43], v[224:227], v[200:203], v[40:43]
  v_mfma_f32_16x16x32_bf16 v[44:47], v[224:227], v[204:207], v[44:47]
  v_mfma_f32_16x16x32_bf16 v[48:51], v[228:231], v[192:195], v[48:51]
  v_mfma_f32_16x16x32_bf16 v[52:55], v[228:231], v[196:199], v[52:55]
  v_mfma_f32_16x16x32_bf16 v[56:59], v[228:231], v[200:203], v[56:59]
  v_mfma_f32_16x16x32_bf16 v[60:63], v[228:231], v[204:207], v[60:63]
  s_waitcnt vmcnt(24)
  v_mfma_f32_16x16x32_bf16 v[64:67], v[232:235], v[192:195], v[64:67]
  ds_read_b64_tr_b16 v[208:209], v16 offset:16384
  v_mfma_f32_16x16x32_bf16 v[68:71], v[232:235], v[196:199], v[68:71]
  ds_read_b64_tr_b16 v[210:211], v16 offset:18432
  v_mfma_f32_16x16x32_bf16 v[72:75], v[232:235], v[200:203], v[72:75]
  ds_read_b64_tr_b16 v[212:213], v17 offset:16384
  v_mfma_f32_16x16x32_bf16 v[76:79], v[232:235], v[204:207], v[76:79]
  ds_read_b64_tr_b16 v[214:215], v17 offset:18432
  v_mfma_f32_16x16x32_bf16 v[80:83], v[236:239], v[192:195], v[80:83]
  ds_read_b64_tr_b16 v[216:217], v18 offset:16384
  v_mfma_f32_16x16x32_bf16 v[84:87], v[236:239], v[196:199], v[84:87]
  ds_read_b64_tr_b16 v[218:219], v18 offset:18432
  v_mfma_f32_16x16x32_bf16 v[88:91], v[236:239], v[200:203], v[88:91]
  ds_read_b64_tr_b16 v[220:221], v19 offset:16384
  v_mfma_f32_16x16x32_bf16 v[92:95], v[236:239], v[204:207], v[92:95]
  ds_read_b64_tr_b16 v[222:223], v19 offset:18432
  s_waitcnt lgkmcnt(0)
  v_mfma_f32_16x16x32_bf16 v[32:35], v[208:211], v[96:99], v[32:35]
  v_mfma_f32_16x16x32_bf16 v[36:39], v[208:211], v[100:103], v[36:39]
  v_mfma_f32_16x16x32_bf16 v[40:43], v[208:211], v[104:107], v[40:43]
  v_mfma_f32_16x16x32_bf16 v[44:47], v[208:211], v[108:111], v[44:47]
  v_mfma_f32_16x16x32_bf16 v[48:51], v[212:215], v[96:99], v[48:51]
  v_mfma_f32_16x16x32_bf16 v[52:55], v[212:215], v[100:103], v[52:55]
  v_mfma_f32_16x16x32_bf16 v[56:59], v[212:215], v[104:107], v[56:59]
  v_mfma_f32_16x16x32_bf16 v[60:63], v[212:215], v[108:111], v[60:63]
  s_waitcnt vmcnt(16)
  v_mfma_f32_16x16x32_bf16 v[64:67], v[216:219], v[96:99], v[64:67]
  ds_read_b64_tr_b16 v[224:225], v16 offset:20480
  v_mfma_f32_16x16x32_bf16 v[68:71], v[216:219], v[100:103], v[68:71]
  ds_read_b64_tr_b16 v[226:227], v16 offset:22528
  v_mfma_f32_16x16x32_bf16 v[72:75], v[216:219], v[104:107], v[72:75]
  ds_read_b64_tr_b16 v[228:229], v17 offset:20480
  v_mfma_f32_16x16x32_bf16 v[76:79], v[216:219], v[108:111], v[76:79]
  ds_read_b64_tr_b16 v[230:231], v17 offset:22528
  v_mfma_f32_16x16x32_bf16 v[80:83], v[220:223], v[96:99], v[80:83]
  ds_read_b64_tr_b16 v[232:233], v18 offset:20480
  v_mfma_f32_16x16x32_bf16 v[84:87], v[220:223], v[100:103], v[84:87]
  ds_read_b64_tr_b16 v[234:235], v18 offset:22528
  v_mfma_f32_16x16x32_bf16 v[88:91], v[220:223], v[104:107], v[88:91]
  ds_read_b64_tr_b16 v[236:237], v19 offset:20480
  v_mfma_f32_16x16x32_bf16 v[92:95], v[220:223], v[108:111], v[92:95]
  ds_read_b64_tr_b16 v[238:239], v19 offset:22528
  s_waitcnt lgkmcnt(0)
  v_mfma_f32_16x16x32_bf16 v[32:35], v[224:227], v[112:115], v[32:35]
  v_mfma_f32_16x16x32_bf16 v[36:39], v[224:227], v[116:119], v[36:39]
  v_mfma_f32_16x16x32_bf16 v[40:43], v[224:227], v[120:123], v[40:43]
  v_mfma_f32_16x16x32_bf16 v[44:47], v[224:227], v[124:127], v[44:47]
  v_mfma_f32_16x16x32_bf16 v[48:51], v[228:231], v[112:115], v[48:51]
  v_mfma_f32_16x16x32_bf16 v[52:55], v[228:231], v[116:119], v[52:55]
  v_mfma_f32_16x16x32_bf16 v[56:59], v[228:231], v[120:123], v[56:59]
  v_mfma_f32_16x16x32_bf16 v[60:63], v[228:231], v[124:127], v[60:63]
  s_waitcnt vmcnt(8)
  v_mfma_f32_16x16x32_bf16 v[64:67], v[232:235], v[112:115], v[64:67]
  ds_read_b64_tr_b16 v[208:209], v16 offset:24576
  v_mfma_f32_16x16x32_bf16 v[68:71], v[232:235], v[116:119], v[68:71]
  ds_read_b64_tr_b16 v[210:211], v16 offset:26624
  v_mfma_f32_16x16x32_bf16 v[72:75], v[232:235], v[120:123], v[72:75]
  ds_read_b64_tr_b16 v[212:213], v17 offset:24576
  v_mfma_f32_16x16x32_bf16 v[76:79], v[232:235], v[124:127], v[76:79]
  ds_read_b64_tr_b16 v[214:215], v17 offset:26624
  v_mfma_f32_16x16x32_bf16 v[80:83], v[236:239], v[112:115], v[80:83]
  ds_read_b64_tr_b16 v[216:217], v18 offset:24576
  v_mfma_f32_16x16x32_bf16 v[84:87], v[236:239], v[116:119], v[84:87]
  ds_read_b64_tr_b16 v[218:219], v18 offset:26624
  v_mfma_f32_16x16x32_bf16 v[88:91], v[236:239], v[120:123], v[88:91]
  ds_read_b64_tr_b16 v[220:221], v19 offset:24576
  v_mfma_f32_16x16x32_bf16 v[92:95], v[236:239], v[124:127], v[92:95]
  ds_read_b64_tr_b16 v[222:223], v19 offset:26624
  s_waitcnt lgkmcnt(0)
  v_mfma_f32_16x16x32_bf16 v[32:35], v[208:211], v[128:131], v[32:35]
  v_mfma_f32_16x16x32_bf16 v[36:39], v[208:211], v[132:135], v[36:39]
  v_mfma_f32_16x16x32_bf16 v[40:43], v[208:211], v[136:139], v[40:43]
  v_mfma_f32_16x16x32_bf16 v[44:47], v[208:211], v[140:143], v[44:47]
  v_mfma_f32_16x16x32_bf16 v[48:51], v[212:215], v[128:131], v[48:51]
  v_mfma_f32_16x16x32_bf16 v[52:55], v[212:215], v[132:135], v[52:55]
  v_mfma_f32_16x16x32_bf16 v[56:59], v[212:215], v[136:139], v[56:59]
  v_mfma_f32_16x16x32_bf16 v[60:63], v[212:215], v[140:143], v[60:63]
  s_waitcnt vmcnt(0)
  v_mfma_f32_16x16x32_bf16 v[64:67], v[216:219], v[128:131], v[64:67]
  ds_read_b64_tr_b16 v[224:225], v16 offset:28672
  v_mfma_f32_16x16x32_bf16 v[68:71], v[216:219], v[132:135], v[68:71]
  ds_read_b64_tr_b16 v[226:227], v16 offset:30720
  v_mfma_f32_16x16x32_bf16 v[72:75], v[216:219], v[136:139], v[72:75]
  ds_read_b64_tr_b16 v[228:229], v17 offset:28672
  v_mfma_f32_16x16x32_bf16 v[76:79], v[216:219], v[140:143], v[76:79]
  ds_read_b64_tr_b16 v[230:231], v17 offset:30720
  v_mfma_f32_16x16x32_bf16 v[80:83], v[220:223], v[128:131], v[80:83]
  ds_read_b64_tr_b16 v[232:233], v18 offset:28672
  v_mfma_f32_16x16x32_bf16 v[84:87], v[220:223], v[132:135], v[84:87]
  ds_read_b64_tr_b16 v[234:235], v18 offset:30720
  v_mfma_f32_16x16x32_bf16 v[88:91], v[220:223], v[136:139], v[88:91]
  ds_read_b64_tr_b16 v[236:237], v19 offset:28672
  v_mfma_f32_16x16x32_bf16 v[92:95], v[220:223], v[140:143], v[92:95]
  ds_read_b64_tr_b16 v[238:239], v19 offset:30720
  s_waitcnt lgkmcnt(0)
  v_mfma_f32_16x16x32_bf16 v[32:35], v[224:227], v[144:147], v[32:35]
  v_mfma_f32_16x16x32_bf16 v[36:39], v[224:227], v[148:151], v[36:39]
  v_mfma_f32_16x16x32_bf16 v[40:43], v[224:227], v[152:155], v[40:43]
  v_mfma_f32_16x16x32_bf16 v[44:47], v[224:227], v[156:159], v[44:47]
  v_mfma_f32_16x16x32_bf16 v[48:51], v[228:231], v[144:147], v[48:51]
  v_mfma_f32_16x16x32_bf16 v[52:55], v[228:231], v[148:151], v[52:55]
  v_mfma_f32_16x16x32_bf16 v[56:59], v[228:231], v[152:155], v[56:59]
  v_mfma_f32_16x16x32_bf16 v[60:63], v[228:231], v[156:159], v[60:63]
  v_mfma_f32_16x16x32_bf16 v[64:67], v[232:235], v[144:147], v[64:67]
  v_mfma_f32_16x16x32_bf16 v[68:71], v[232:235], v[148:151], v[68:71]
  v_mfma_f32_16x16x32_bf16 v[72:75], v[232:235], v[152:155], v[72:75]
  v_mfma_f32_16x16x32_bf16 v[76:79], v[232:235], v[156:159], v[76:79]
  v_mfma_f32_16x16x32_bf16 v[80:83], v[236:239], v[144:147], v[80:83]
  v_mfma_f32_16x16x32_bf16 v[84:87], v[236:239], v[148:151], v[84:87]
  v_mfma_f32_16x16x32_bf16 v[88:91], v[236:239], v[152:155], v[88:91]
  v_mfma_f32_16x16x32_bf16 v[92:95], v[236:239], v[156:159], v[92:95]
  s_nop 7
  s_barrier
  v_mul_u32_u24 v7, 272, v4
  v_lshl_add_u32 v7, v3, 4, v7
  s_mul_i32 s45, s3, 17408
  v_add_u32 v7, s45, v7
  ds_write_b128 v7, v[32:35] offset:0
  ds_write_b128 v7, v[36:39] offset:4352
  ds_write_b128 v7, v[40:43] offset:8704
  ds_write_b128 v7, v[44:47] offset:13056
  ds_write_b128 v7, v[48:51] offset:64
  ds_write_b128 v7, v[52:55] offset:4416
  ds_write_b128 v7, v[56:59] offset:8768
  ds_write_b128 v7, v[60:63] offset:13120
  ds_write_b128 v7, v[64:67] offset:128
  ds_write_b128 v7, v[68:71] offset:4480
  ds_write_b128 v7, v[72:75] offset:8832
  ds_write_b128 v7, v[76:79] offset:13184
  ds_write_b128 v7, v[80:83] offset:192
  ds_write_b128 v7, v[84:87] offset:4544
  ds_write_b128 v7, v[88:91] offset:8896
  ds_write_b128 v7, v[92:95] offset:13248
  s_lshl_b32 s45, s3, 6
  v_add_u32 v0, s45, v2
  s_waitcnt lgkmcnt(0)
  s_barrier
  v_lshrrev_b32 v7, 3, v0
  v_and_b32 v8, 7, v0
  v_mul_u32_u24 v9, 272, v7
  v_lshl_add_u32 v9, v8, 5, v9
  ds_read_b128 v[96:99], v9 offset:0
  ds_read_b128 v[100:103], v9 offset:16
  ds_read_b128 v[104:107], v9 offset:17408
  ds_read_b128 v[108:111], v9 offset:17424
  ds_read_b128 v[112:115], v9 offset:34816
  ds_read_b128 v[116:119], v9 offset:34832
  ds_read_b128 v[120:123], v9 offset:52224
  ds_read_b128 v[124:127], v9 offset:52240
  ds_read_b128 v[128:131], v9 offset:8704
  ds_read_b128 v[132:135], v9 offset:8720
  ds_read_b128 v[136:139], v9 offset:26112
  ds_read_b128 v[140:143], v9 offset:26128
  ds_read_b128 v[144:147], v9 offset:43520
  ds_read_b128 v[148:151], v9 offset:43536
  ds_read_b128 v[152:155], v9 offset:60928
  ds_read_b128 v[156:159], v9 offset:60944
  s_mul_i32 s45, s57, 192
  s_lshl_b32 s46, s76, 6
  s_add_u32 s45, s45, s46
  s_mul_i32 s45, s45, 1152
  s_lshl_b32 s46, s77, 7
  s_add_u32 s45, s45, s46
  v_mul_u32_u24 v7, 1152, v7
  v_lshl_add_u32 v7, v8, 4, v7
  s_waitcnt lgkmcnt(8)
  v_pk_add_f32 v[96:97], v[96:97], v[104:105]
  v_pk_add_f32 v[98:99], v[98:99], v[106:107]
  v_pk_add_f32 v[100:101], v[100:101], v[108:109]
  v_pk_add_f32 v[102:103], v[102:103], v[110:111]
  v_pk_add_f32 v[96:97], v[96:97], v[112:113]
  v_pk_add_f32 v[98:99], v[98:99], v[114:115]
  v_pk_add_f32 v[100:101], v[100:101], v[116:117]
  v_pk_add_f32 v[102:103], v[102:103], v[118:119]
  v_pk_add_f32 v[96:97], v[96:97], v[120:121]
  v_pk_add_f32 v[98:99], v[98:99], v[122:123]
  v_pk_add_f32 v[100:101], v[100:101], v[124:125]
  v_pk_add_f32 v[102:103], v[102:103], v[126:127]
  v_cvt_pk_bf16_f32 v96, v96, v97
  v_cvt_pk_bf16_f32 v97, v98, v99
  v_cvt_pk_bf16_f32 v98, v100, v101
  v_cvt_pk_bf16_f32 v99, v102, v103
  s_add_u32 s46, s45, 0
  buffer_store_dwordx4 v[96:99], v7, s[16:19], s46 offen nt
  s_waitcnt lgkmcnt(0)
  v_pk_add_f32 v[128:129], v[128:129], v[136:137]
  v_pk_add_f32 v[130:131], v[130:131], v[138:139]
  v_pk_add_f32 v[132:133], v[132:133], v[140:141]
  v_pk_add_f32 v[134:135], v[134:135], v[142:143]
  v_pk_add_f32 v[128:129], v[128:129], v[144:145]
  v_pk_add_f32 v[130:131], v[130:131], v[146:147]
  v_pk_add_f32 v[132:133], v[132:133], v[148:149]
  v_pk_add_f32 v[134:135], v[134:135], v[150:151]
  v_pk_add_f32 v[128:129], v[128:129], v[152:153]
  v_pk_add_f32 v[130:131], v[130:131], v[154:155]
  v_pk_add_f32 v[132:133], v[132:133], v[156:157]
  v_pk_add_f32 v[134:135], v[134:135], v[158:159]
  v_cvt_pk_bf16_f32 v128, v128, v129
  v_cvt_pk_bf16_f32 v129, v130, v131
  v_cvt_pk_bf16_f32 v130, v132, v133
  v_cvt_pk_bf16_f32 v131, v134, v135
  s_add_u32 s46, s45, 36864
  buffer_store_dwordx4 v[128:131], v7, s[16:19], s46 offen nt
  s_branch L_fin
L_notile:
  s_waitcnt vmcnt(0)
  s_barrier
  s_cmp_eq_u32 s3, 0
  s_cbranch_scc0 L_pub2
  s_mov_b64 exec, 0x7ffffff
  global_atomic_add v24, v23, s[94:95]
  s_mov_b64 exec, -1
L_pub2:
L_fin:
  s_waitcnt vmcnt(0)
L_k1_end:
  s_endpgm
L_fallback:
  s_waitcnt vmcnt(0) lgkmcnt(0)
  s_mov_b32 s41, 1
  s_mov_b32 s92, 99
  s_barrier
  s_branch L_restart
L_maxpass:
  v_mov_b32 v168, 0
  v_mov_b32 v169, 0
  v_mov_b32 v170, 0
  v_mov_b32 v171, 0
  v_mov_b32 v172, 0
  v_mov_b32 v173, 0
  v_mov_b32 v174, 0
  v_mov_b32 v175, 0
  v_mov_b32 v176, 0
  v_mov_b32 v177, 0
  v_mov_b32 v178, 0
  v_mov_b32 v179, 0
  v_mov_b32 v180, 0
  v_mov_b32 v181, 0
  v_mov_b32 v182, 0
  v_mov_b32 v183, 0
  v_mov_b32 v184, 0
  v_mov_b32 v185, 0
  v_mov_b32 v186, 0
  v_mov_b32 v187, 0
  v_mov_b32 v188, 0
  v_mov_b32 v189, 0
  v_mov_b32 v190, 0
  v_mov_b32 v191, 0
  v_mov_b32 v136, 0
  v_mov_b32 v137, 0
  v_mov_b32 v138, 0
  v_mov_b32 v139, 0
  v_mov_b32 v140, 0
  v_mov_b32 v141, 0
  v_mov_b32 v142, 0
  v_mov_b32 v143, 0
  v_mov_b32 v144, 0xff800000
  v_mov_b32 v148, 0xff800000
  v_mov_b32 v152, 0xff800000
  v_mov_b32 v156, 0xff800000
  v_mov_b32 v160, 0xff800000
  v_mov_b32 v164, 0xff800000
  s_mov_b32 s40, 0
  s_mov_b32 s45, s43
  s_waitcnt vmcnt(0) lgkmcnt(0)
  s_barrier
L_mp_loop:
  s_add_u32 m0, s43, 98304
  s_nop 0
  buffer_load_dwordx4 v220, s[8:11], s45 offen offset:0 lds
  buffer_load_dwordx4 v221, s[8:11], s45 offen offset:1024 lds
  buffer_load_dwordx4 v222, s[8:11], s45 offen offset:2048 lds
  buffer_load_dwordx4 v223, s[8:11], s45 offen offset:3072 lds
  s_waitcnt vmcnt(0)
  s_barrier
  ds_read_b128 a[192:195], v200 offset:32768
  ds_read_b128 a[196:199], v200 offset:36864
  ds_read_b128 a[200:203], v201 offset:32768
  ds_read_b128 a[204:207], v201 offset:36864
  ds_read_b128 a[208:211], v202 offset:32768
  ds_read_b128 a[212:215], v202 offset:36864
  ds_read_b128 a[216:219], v203 offset:32768
  ds_read_b128 a[220:223], v203 offset:36864
  s_waitcnt lgkmcnt(0)
  s_barrier
  v_mfma_f32_16x16x32_bf16 v[96:99], a[192:195], v[0:3], 0
  v_mfma_f32_16x16x32_bf16 v[100:103], a[192:195], v[16:19], 0
  v_mfma_f32_16x16x32_bf16 v[104:107], a[196:199], v[0:3], 0
  v_mfma_f32_16x16x32_bf16 v[108:111], a[196:199], v[16:19], 0
  v_mfma_f32_16x16x32_bf16 v[96:99], a[200:203], v[4:7], v[96:99]
  v_mfma_f32_16x16x32_bf16 v[100:103], a[200:203], v[20:23], v[100:103]
  v_mfma_f32_16x16x32_bf16 v[104:107], a[204:207], v[4:7], v[104:107]
  v_mfma_f32_16x16x32_bf16 v[108:111], a[204:207], v[20:23], v[108:111]
  v_mfma_f32_16x16x32_bf16 v[96:99], a[208:211], v[8:11], v[96:99]
  v_mfma_f32_16x16x32_bf16 v[100:103], a[208:211], v[24:27], v[100:103]
  v_mfma_f32_16x16x32_bf16 v[104:107], a[212:215], v[8:11], v[104:107]
  v_mfma_f32_16x16x32_bf16 v[108:111], a[212:215], v[24:27], v[108:111]
  v_mfma_f32_16x16x32_bf16 v[96:99], a[216:219], v[12:15], v[96:99]
  v_mfma_f32_16x16x32_bf16 v[100:103], a[216:219], v[28:31], v[100:103]
  v_mfma_f32_16x16x32_bf16 v[104:107], a[220:223], v[12:15], v[104:107]
  v_mfma_f32_16x16x32_bf16 v[108:111], a[220:223], v[28:31], v[108:111]
  s_nop 7
  v_max3_f32 v144, v144, v96, v97
  v_max3_f32 v144, v144, v98, v99
  v_max3_f32 v144, v144, v104, v105
  v_max3_f32 v144, v144, v106, v107
  v_max3_f32 v148, v148, v100, v101
  v_max3_f32 v148, v148, v102, v103
  v_max3_f32 v148, v148, v108, v109
  v_max3_f32 v148, v148, v110, v111
  s_nop 1
  v_mfma_f32_16x16x32_bf16 v[96:99], a[192:195], v[32:35], 0
  v_mfma_f32_16x16x32_bf16 v[100:103], a[192:195], v[48:51], 0
  v_mfma_f32_16x16x32_bf16 v[104:107], a[196:199], v[32:35], 0
  v_mfma_f32_16x16x32_bf16 v[108:111], a[196:199], v[48:51], 0
  v_mfma_f32_16x16x32_bf16 v[96:99], a[200:203], v[36:39], v[96:99]
  v_mfma_f32_16x16x32_bf16 v[100:103], a[200:203], v[52:55], v[100:103]
  v_mfma_f32_16x16x32_bf16 v[104:107], a[204:207], v[36:39], v[104:107]
  v_mfma_f32_16x16x32_bf16 v[108:111], a[204:207], v[52:55], v[108:111]
  v_mfma_f32_16x16x32_bf16 v[96:99], a[208:211], v[40:43], v[96:99]
  v_mfma_f32_16x16x32_bf16 v[100:103], a[208:211], v[56:59], v[100:103]
  v_mfma_f32_16x16x32_bf16 v[104:107], a[212:215], v[40:43], v[104:107]
  v_mfma_f32_16x16x32_bf16 v[108:111], a[212:215], v[56:59], v[108:111]
  v_mfma_f32_16x16x32_bf16 v[96:99], a[216:219], v[44:47], v[96:99]
  v_mfma_f32_16x16x32_bf16 v[100:103], a[216:219], v[60:63], v[100:103]
  v_mfma_f32_16x16x32_bf16 v[104:107], a[220:223], v[44:47], v[104:107]
  v_mfma_f32_16x16x32_bf16 v[108:111], a[220:223], v[60:63], v[108:111]
  s_nop 7
  v_max3_f32 v152, v152, v96, v97
  v_max3_f32 v152, v152, v98, v99
  v_max3_f32 v152, v152, v104, v105
  v_max3_f32 v152, v152, v106, v107
  v_max3_f32 v156, v156, v100, v101
  v_max3_f32 v156, v156, v102, v103
  v_max3_f32 v156, v156, v108, v109
  v_max3_f32 v156, v156, v110, v111
  s_nop 1
  v_mfma_f32_16x16x32_bf16 v[96:99], a[192:195], v[64:67], 0
  v_mfma_f32_16x16x32_bf16 v[100:103], a[192:195], v[80:83], 0
  v_mfma_f32_16x16x32_bf16 v[104:107], a[196:199], v[64:67], 0
  v_mfma_f32_16x16x32_bf16 v[108:111], a[196:199], v[80:83], 0
  v_mfma_f32_16x16x32_bf16 v[96:99], a[200:203], v[68:71], v[96:99]
  v_mfma_f32_16x16x32_bf16 v[100:103], a[200:203], v[84:87], v[100:103]
  v_mfma_f32_16x16x32_bf16 v[104:107], a[204:207], v[68:71], v[104:107]
  v_mfma_f32_16x16x32_bf16 v[108:111], a[204:207], v[84:87], v[108:111]
  v_mfma_f32_16x16x32_bf16 v[96:99], a[208:211], v[72:75], v[96:99]
  v_mfma_f32_16x16x32_bf16 v[100:103], a[208:211], v[88:91], v[100:103]
  v_mfma_f32_16x16x32_bf16 v[104:107], a[212:215], v[72:75], v[104:107]
  v_mfma_f32_16x16x32_bf16 v[108:111], a[212:215], v[88:91], v[108:111]
  v_mfma_f32_16x16x32_bf16 v[96:99], a[216:219], v[76:79], v[96:99]
  v_mfma_f32_16x16x32_bf16 v[100:103], a[216:219], v[92:95], v[100:103]
  v_mfma_f32_16x16x32_bf16 v[104:107], a[220:223], v[76:79], v[104:107]
  v_mfma_f32_16x16x32_bf16 v[108:111], a[220:223], v[92:95], v[108:111]
  s_nop 7
  v_max3_f32 v160, v160, v96, v97
  v_max3_f32 v160, v160, v98, v99
  v_max3_f32 v160, v160, v104, v105
  v_max3_f32 v160, v160, v106, v107
  v_max3_f32 v164, v164, v100, v101
  v_max3_f32 v164, v164, v102, v103
  v_max3_f32 v164, v164, v108, v109
  v_max3_f32 v164, v164, v110, v111
  s_nop 1
  s_add_u32 s45, s45, 16384
  s_add_u32 s40, s40, 1
  s_cmp_lt_u32 s40, 32
  s_cbranch_scc1 L_mp_loop
  v_mov_b32 v145, v144
  v_mov_b32 v149, v148
  v_mov_b32 v153, v152
  v_mov_b32 v157, v156
  v_mov_b32 v161, v160
  v_mov_b32 v165, v164
  s_nop 1
  v_permlane32_swap_b32 v144, v145
  v_permlane32_swap_b32 v148, v149
  v_permlane32_swap_b32 v152, v153
  v_permlane32_swap_b32 v156, v157
  v_permlane32_swap_b32 v160, v161
  v_permlane32_swap_b32 v164, v165
  s_nop 1
  v_max_f32 v144, v144, v145
  v_max_f32 v148, v148, v149
  v_max_f32 v152, v152, v153
  v_max_f32 v156, v156, v157
  v_max_f32 v160, v160, v161
  v_max_f32 v164, v164, v165
  v_mov_b32 v145, v144
  v_mov_b32 v149, v148
  v_mov_b32 v153, v152
  v_mov_b32 v157, v156
  v_mov_b32 v161, v160
  v_mov_b32 v165, v164
  s_nop 1
  v_permlane16_swap_b32 v144, v145
  v_permlane16_swap_b32 v148, v149
  v_permlane16_swap_b32 v152, v153
  v_permlane16_swap_b32 v156, v157
  v_permlane16_swap_b32 v160, v161
  v_permlane16_swap_b32 v164, v165
  s_nop 1
  v_max_f32 v144, v144, v145
  v_max_f32 v148, v148, v149
  v_max_f32 v152, v152, v153
  v_max_f32 v156, v156, v157
  v_max_f32 v160, v160, v161
  v_max_f32 v164, v164, v165
  v_sub_f32 v144, 0, v144
  v_sub_f32 v148, 0, v148
  v_sub_f32 v152, 0, v152
  v_sub_f32 v156, 0, v156
  v_sub_f32 v160, 0, v160
  v_sub_f32 v164, 0, v164
  v_mov_b32 v145, v144
  v_mov_b32 v146, v144
  v_mov_b32 v147, v144
  v_mov_b32 v149, v148
  v_mov_b32 v150, v148
  v_mov_b32 v151, v148
  v_mov_b32 v153, v152
  v_mov_b32 v154, v152
  v_mov_b32 v155, v152
  v_mov_b32 v157, v156
  v_mov_b32 v158, v156
  v_mov_b32 v159, v156
  v_mov_b32 v161, v160
  v_mov_b32 v162, v160
  v_mov_b32 v163, v160
  v_mov_b32 v165, v164
  v_mov_b32 v166, v164
  v_mov_b32 v167, v164
  s_add_u32 m0, s43, 98304
  s_nop 0
  buffer_load_dwordx4 v220, s[8:11], s43 offen offset:0 lds
  buffer_load_dwordx4 v221, s[8:11], s43 offen offset:1024 lds
  buffer_load_dwordx4 v222, s[8:11], s43 offen offset:2048 lds
  buffer_load_dwordx4 v223, s[8:11], s43 offen offset:3072 lds
  s_waitcnt vmcnt(0)
  s_barrier
  ds_read_b128 a[192:195], v200 offset:32768
  ds_read_b128 a[196:199], v200 offset:36864
  ds_read_b128 a[200:203], v201 offset:32768
  ds_read_b128 a[204:207], v201 offset:36864
  ds_read_b128 a[208:211], v202 offset:32768
  ds_read_b128 a[212:215], v202 offset:36864
  ds_read_b128 a[216:219], v203 offset:32768
  ds_read_b128 a[220:223], v203 offset:36864
  s_waitcnt lgkmcnt(0)
  s_branch L_join
.section .rodata,"a"
.p2align 6
.amdhsa_kernel standalone__mha_block_cached__near_ridge_kernel
  .amdhsa_next_free_vgpr 512
  .amdhsa_next_free_sgpr 102
  .amdhsa_accum_offset 256
  .amdhsa_group_segment_fixed_size 0
  .amdhsa_kernarg_size 64
  .amdhsa_user_sgpr_count 2
  .amdhsa_user_sgpr_kernarg_segment_ptr 1
  .amdhsa_system_sgpr_workgroup_id_x 1
  .amdhsa_float_denorm_mode_32 3
.end_amdhsa_kernel
```
